```python
import torch

def _softmax(x, axis=-1):
    return torch.softmax(x, dim=axis)
def _gelu(x):
    return torch.nn.functional.gelu(x, approximate="tanh")
def _silu(x):
    return torch.nn.functional.silu(x)
def _sigmoid(x):
    return torch.sigmoid(x)
def _layernorm(x, axis=-1, eps=1e-5):
    m = x.mean(dim=axis, keepdim=True)
    v = x.var(dim=axis, keepdim=True, unbiased=False)
    return (x - m) / torch.sqrt(v + eps)
def _scatter_add(tgt, idx, src, axis=0):
    return tgt.clone().index_add_(axis, idx, src)
def _segment_sum(src, seg, n):
    out = torch.zeros((n,) + src.shape[1:], dtype=src.dtype)
    return out.index_add_(0, seg, src)
def _pad(x, pw):
    flat = tuple(v for pair in reversed(pw) for v in pair)
    return torch.nn.functional.pad(x, flat)

kernel_name = 'gated_mix__mha_block_cached__gqa_block_cached__decode'

def setup_inputs():

    _w = (lambda a: (lambda t: t.to(torch.bfloat16) if t.is_floating_point() else t)(torch.as_tensor(a)))
    def _A_setup():
        B, Sq, D = 1, 1, 448
        H, Sk, Dh = 16, 8192, 256
        return {
            "x": _w((lambda *s: torch.randn(*s, dtype=torch.bfloat16) * 0.05)(B, Sq, D)),
            "k_cache": _w((lambda *s: torch.randn(*s, dtype=torch.bfloat16) * 3.2)(B, H, Sk, Dh)),
            "v_cache": _w((lambda *s: torch.randn(*s, dtype=torch.bfloat16) * 0.1)(B, H, Sk, Dh)),
            "wq": _w((lambda *s: torch.randn(*s, dtype=torch.bfloat16) * 3.2)(D, H * Dh) * (D ** -0.5)),
            "wo": _w((lambda *s: torch.randn(*s, dtype=torch.bfloat16) * 0.1)(H * Dh, D) * ((H * Dh) ** -0.5)),
        }
    _A_in = _A_setup()

    def _B_setup():
        B, Sq, D = 1, 1, 448
        Hq, Hkv, Sk, Dh = 16, 8, 8192, 256
        assert Hq % Hkv == 0, (Hq, Hkv)
        return {
            "x": _w((lambda *s: torch.randn(*s, dtype=torch.bfloat16) * 0.05)(B, Sq, D)),
            "k_cache": _w((lambda *s: torch.randn(*s, dtype=torch.bfloat16) * 3.2)(B, Hkv, Sk, Dh)),
            "v_cache": _w((lambda *s: torch.randn(*s, dtype=torch.bfloat16) * 0.05)(B, Hkv, Sk, Dh)),
            "wq": _w((lambda *s: torch.randn(*s, dtype=torch.bfloat16) * 3.2)(D, Hq * Dh) * (D ** -0.5)),
            "wo": _w((lambda *s: torch.randn(*s, dtype=torch.bfloat16) * 0.05)(Hq * Dh, D) * ((Hq * Dh) ** -0.5)),
        }
    _B_in = _B_setup()

    return {
        "A_x": _A_in["x"],
        "A_k_cache": _A_in["k_cache"],
        "A_v_cache": _A_in["v_cache"],
        "A_wq": _A_in["wq"],
        "A_wo": _A_in["wo"],
        "B_x": _B_in["x"],
        "B_k_cache": _B_in["k_cache"],
        "B_v_cache": _B_in["v_cache"],
        "B_wq": _B_in["wq"],
        "B_wo": _B_in["wo"],
        "gate_w": _w((lambda *s: torch.randn(*s, dtype=torch.bfloat16) * 0.1)(448) * 16.0),
    }

def reference(A_x, A_k_cache, A_v_cache, A_wq, A_wo, B_x, B_k_cache, B_v_cache, B_wq, B_wo, gate_w):
    def _A_ref(x, k_cache, v_cache, wq, wo):
        B, Sq, D = x.shape
        H, Dh = 16, 256
        q = (lambda x, *d: x.permute(*d))((x @ wq).reshape(B, Sq, H, Dh), 0, 2, 1, 3)
        scores = torch.einsum("bhqd,bhkd->bhqk", q, k_cache) * (Dh ** -0.5)
        p = _softmax(scores, axis=-1)
        o = torch.einsum("bhqk,bhkd->bhqd", p, v_cache)
        return (lambda x, *d: x.permute(*d))(o, 0, 2, 1, 3).reshape(B, Sq, H * Dh) @ wo

    def _B_ref(x, k_cache, v_cache, wq, wo):
        B, Sq, D = x.shape
        Hq, Dh = 16, 256
        Hkv = k_cache.shape[1]
        rep = Hq // Hkv
        q = (lambda x, *d: x.permute(*d))((x @ wq).reshape(B, Sq, Hq, Dh), 0, 2, 1, 3)
        k = (lambda x, n, axis: torch.repeat_interleave(x, n, dim=axis))(k_cache, rep, axis=1)
        v = (lambda x, n, axis: torch.repeat_interleave(x, n, dim=axis))(v_cache, rep, axis=1)
        scores = torch.einsum("bhqd,bhkd->bhqk", q, k) * (Dh ** -0.5)
        p = _softmax(scores, axis=-1)
        o = torch.einsum("bhqk,bhkd->bhqd", p, v)
        return (lambda x, *d: x.permute(*d))(o, 0, 2, 1, 3).reshape(B, Sq, Hq * Dh) @ wo

    x = A_x
    g = _sigmoid((x * gate_w).sum(-1, keepdims=True))
    a = _A_ref(x, A_k_cache, A_v_cache, A_wq, A_wo)
    b = _B_ref(x, B_k_cache, B_v_cache, B_wq, B_wo)
    return g * a + (1 - g) * b
```

```asm
; @launch grid=(256,1,1) block=(768,1,1) lds=41984
.amdgcn_target "amdgcn-amd-amdhsa--gfx950"
.text
.globl gated_mix__mha_block_cached__gqa_block_cached__decode_kernel
.p2align 8
.type gated_mix__mha_block_cached__gqa_block_cached__decode_kernel,@function
gated_mix__mha_block_cached__gqa_block_cached__decode_kernel:
  s_cmp_ge_u32 s2, 256
  s_cbranch_scc1 L_end
  s_load_dwordx16 s[8:23], s[0:1], 0
  s_load_dwordx8 s[24:31], s[0:1], 64
  s_load_dwordx4 s[32:35], s[0:1], 96
  v_readfirstlane_b32 s62, v0
  v_and_b32 v1, 63, v0
  v_lshlrev_b32 v1, 4, v1
  s_and_b32 s3, s2, 7
  s_lshr_b32 s5, s2, 3
  s_lshr_b32 s63, s62, 6
  s_cmp_lt_u32 s63, 4
  s_cbranch_scc1 L_serv
  s_sub_u32 s4, s63, 4
  s_lshl_b32 s60, s4, 10
  s_add_u32 s61, s60, 8192
  s_add_u32 s68, s60, 16384
  s_add_u32 s69, s60, 24576
  s_lshl_b32 s6, s3, 22
  s_lshl_b32 s7, s5, 17
  s_add_u32 s6, s6, s7
  s_add_u32 s7, s6, 0x2000000
  s_mov_b32 s38, 0x20000
  s_mov_b32 s39, 0x20000
  s_mov_b32 s42, 0x20000
  s_mov_b32 s43, 0x20000
  s_memrealtime s[54:55]
  s_mov_b64 vcc, 0
  s_waitcnt lgkmcnt(0)
  s_add_u32 s36, s10, s6
  s_addc_u32 s37, s11, 0
  s_add_u32 s40, s12, s6
  s_addc_u32 s41, s13, 0
  buffer_load_dwordx4 v[4:7], v1, s[36:39], s60 offen nt
  buffer_load_dwordx4 v[8:11], v1, s[36:39], s61 offen nt
  buffer_load_dwordx4 v[12:15], v1, s[36:39], s68 offen nt
  s_load_dword s52, s[34:35], 0
  s_mov_b32 s46, 0x20000
  s_mov_b32 s47, 0x20000
  s_mov_b32 s50, 0x20000
  s_mov_b32 s51, 0x20000
  s_add_u32 s44, s20, s6
  s_addc_u32 s45, s21, 0
  s_add_u32 s48, s22, s6
  s_addc_u32 s49, s23, 0
  s_mov_b32 s74, 0x20000
  s_mov_b32 s75, 0x20000
  s_mov_b32 s78, 0x20000
  s_mov_b32 s79, 0x20000
  s_add_u32 s72, s10, s7
  s_addc_u32 s73, s11, 0
  s_add_u32 s76, s12, s7
  s_addc_u32 s77, s13, 0
  s_mov_b32 s56, s34
  s_mov_b32 s57, s35
  s_mov_b32 s58, 4194304
  s_mov_b32 s59, 0x20000
  s_mov_b32 s66, 0xffff0000
  s_mov_b32 s67, 1035512379
  v_and_b32 v2, 31, v0
  v_lshlrev_b32 v2, 4, v2
  v_mov_b32 v162, 0
  s_lshl_b32 s70, s3, 5
  s_add_u32 s70, s70, s5
  s_mul_i32 s70, s70, 1152
  s_add_u32 s70, s70, 1048576
  s_lshl_b32 s12, s3, 7
  s_add_u32 s12, s12, s5
  s_lshl_b32 s12, s12, 3
  s_add_u32 s12, s12, 983296
  s_add_u32 s14, s60, 32768
  s_add_u32 s15, s60, 40960
  s_add_u32 s16, s60, 49152
  s_add_u32 s17, s60, 57344
  s_add_u32 s18, s60, 65536
  s_add_u32 s19, s60, 73728
  s_add_u32 s20, s60, 81920
  s_add_u32 s21, s60, 90112
  s_add_u32 s22, s60, 98304
  s_add_u32 s23, s60, 106496
  s_add_u32 s24, s60, 114688
  s_add_u32 s25, s60, 122880
  s_barrier
  s_waitcnt vmcnt(2)
  buffer_load_dwordx4 v[16:19], v1, s[36:39], s69 offen nt
  s_waitcnt vmcnt(2)
  buffer_load_dwordx4 v[20:23], v1, s[36:39], s14 offen nt
  s_waitcnt vmcnt(2)
  buffer_load_dwordx4 v[24:27], v1, s[36:39], s15 offen nt
  s_waitcnt vmcnt(2)
  buffer_load_dwordx4 v[28:31], v1, s[36:39], s16 offen nt
  s_waitcnt vmcnt(2)
  buffer_load_dwordx4 v[32:35], v1, s[36:39], s17 offen nt
  s_waitcnt vmcnt(2)
  buffer_load_dwordx4 v[36:39], v1, s[36:39], s18 offen nt
  s_waitcnt vmcnt(2)
  buffer_load_dwordx4 v[40:43], v1, s[36:39], s19 offen nt
  s_waitcnt vmcnt(2)
  buffer_load_dwordx4 v[44:47], v1, s[36:39], s20 offen nt
  s_waitcnt vmcnt(2)
  buffer_load_dwordx4 v[48:51], v1, s[36:39], s21 offen nt
  s_waitcnt vmcnt(2)
  buffer_load_dwordx4 v[52:55], v1, s[36:39], s22 offen nt
  s_waitcnt vmcnt(2)
  buffer_load_dwordx4 v[56:59], v1, s[36:39], s23 offen nt
  s_waitcnt vmcnt(2)
  buffer_load_dwordx4 v[60:63], v1, s[36:39], s24 offen nt
  s_waitcnt vmcnt(2)
  buffer_load_dwordx4 v[64:67], v1, s[36:39], s25 offen nt
  s_waitcnt vmcnt(2)
  buffer_load_dwordx4 v[68:71], v1, s[40:43], s60 offen nt
  s_memrealtime s[82:83]
  s_waitcnt vmcnt(2)
  buffer_load_dwordx4 v[72:75], v1, s[40:43], s61 offen nt
  s_waitcnt lgkmcnt(0)
  s_sub_u32 s80, s82, s54
  s_sub_u32 s80, s80, 687
  s_cmp_gt_i32 s80, 80
  s_cselect_b64 vcc, 1, 0
  s_cmp_gt_i32 s80, 0
  s_waitcnt vmcnt(4)
  s_cbranch_vccnz L_bz1
  s_waitcnt vmcnt(2)
  s_cbranch_scc1 L_bz1
  s_waitcnt vmcnt(1)
L_bz1:
  buffer_load_dwordx4 v[76:79], v1, s[40:43], s68 offen nt
  s_waitcnt vmcnt(4)
  s_cbranch_vccnz L_bz2
  s_waitcnt vmcnt(2)
  s_cbranch_scc1 L_bz2
  s_waitcnt vmcnt(1)
L_bz2:
  buffer_load_dwordx4 v[80:83], v1, s[40:43], s69 offen nt
  s_waitcnt vmcnt(4)
  s_cbranch_vccnz L_bz3
  s_waitcnt vmcnt(2)
  s_cbranch_scc1 L_bz3
  s_waitcnt vmcnt(1)
L_bz3:
  buffer_load_dwordx4 v[84:87], v1, s[40:43], s14 offen nt
  s_memrealtime s[82:83]
  s_waitcnt vmcnt(4)
  s_cbranch_vccnz L_bz4
  s_waitcnt vmcnt(2)
  s_cbranch_scc1 L_bz4
  s_waitcnt vmcnt(1)
L_bz4:
  buffer_load_dwordx4 v[88:91], v1, s[40:43], s15 offen nt
  s_waitcnt lgkmcnt(0)
  s_sub_u32 s80, s82, s54
  s_sub_u32 s80, s80, 794
  s_cmp_gt_i32 s80, 80
  s_cselect_b64 vcc, 1, 0
  s_cmp_gt_i32 s80, 0
  s_waitcnt vmcnt(4)
  s_cbranch_vccnz L_bz5
  s_waitcnt vmcnt(2)
  s_cbranch_scc1 L_bz5
  s_waitcnt vmcnt(1)
L_bz5:
  buffer_load_dwordx4 v[92:95], v1, s[40:43], s16 offen nt
  s_waitcnt vmcnt(4)
  s_cbranch_vccnz L_bz6
  s_waitcnt vmcnt(2)
  s_cbranch_scc1 L_bz6
  s_waitcnt vmcnt(1)
L_bz6:
  buffer_load_dwordx4 v[96:99], v1, s[40:43], s17 offen nt
  s_waitcnt vmcnt(4)
  s_cbranch_vccnz L_bz7
  s_waitcnt vmcnt(2)
  s_cbranch_scc1 L_bz7
  s_waitcnt vmcnt(1)
L_bz7:
  buffer_load_dwordx4 v[100:103], v1, s[40:43], s18 offen nt
  s_memrealtime s[82:83]
  s_waitcnt vmcnt(4)
  s_cbranch_vccnz L_bz8
  s_waitcnt vmcnt(2)
  s_cbranch_scc1 L_bz8
  s_waitcnt vmcnt(1)
L_bz8:
  buffer_load_dwordx4 v[104:107], v1, s[40:43], s19 offen nt
  s_waitcnt lgkmcnt(0)
  s_sub_u32 s80, s82, s54
  s_sub_u32 s80, s80, 900
  s_cmp_gt_i32 s80, 80
  s_cselect_b64 vcc, 1, 0
  s_cmp_gt_i32 s80, 0
  s_waitcnt vmcnt(4)
  s_cbranch_vccnz L_bz9
  s_waitcnt vmcnt(2)
  s_cbranch_scc1 L_bz9
  s_waitcnt vmcnt(1)
L_bz9:
  buffer_load_dwordx4 v[108:111], v1, s[40:43], s20 offen nt
  s_waitcnt vmcnt(4)
  s_cbranch_vccnz L_bz10
  s_waitcnt vmcnt(2)
  s_cbranch_scc1 L_bz10
  s_waitcnt vmcnt(1)
L_bz10:
  buffer_load_dwordx4 v[112:115], v1, s[40:43], s21 offen nt
  s_waitcnt lgkmcnt(0)
  s_mul_i32 s53, s52, 0x9E3779B1
  s_add_u32 s53, s53, 0x7F4A7C15
  s_lshl_b32 s64, s4, 10
  v_lshrrev_b32 v163, 9, v1
  v_lshlrev_b32 v163, 4, v163
  v_lshl_add_u32 v163, v2, 1, v163
  v_add_u32 v163, s64, v163
  s_lshl_b32 s64, s4, 3
  v_mov_b32 v164, s64
  v_mov_b32 v3, 1
  s_mov_b32 s65, 524288
L_lw11:
  ds_read_b32 v148, v162 offset:4096
  s_waitcnt lgkmcnt(0)
  v_cmp_ne_u32 vcc, 1, v148
  s_cbranch_vccz L_lwok11
  s_sleep 1
  s_sub_u32 s65, s65, 1
  s_cmp_lg_u32 s65, 0
  s_cbranch_scc1 L_lw11
L_lwok11:
  ds_read_b128 v[120:123], v2 offset:0
  s_waitcnt lgkmcnt(0)
  s_cmp_gt_i32 s80, 80
  s_cselect_b64 vcc, 1, 0
  s_cmp_gt_i32 s80, 0
  v_dot2_f32_bf16 v132, v4, v120, 0
  v_dot2_f32_bf16 v132, v5, v121, v132
  v_dot2_f32_bf16 v132, v6, v122, v132
  v_dot2_f32_bf16 v132, v7, v123, v132
  s_waitcnt vmcnt(4)
  s_cbranch_vccnz L_bz12
  s_waitcnt vmcnt(2)
  s_cbranch_scc1 L_bz12
  s_waitcnt vmcnt(1)
L_bz12:
  buffer_load_dwordx4 v[4:7], v1, s[40:43], s22 offen nt
  s_memrealtime s[82:83]
  v_dot2_f32_bf16 v148, v8, v120, 0
  v_dot2_f32_bf16 v148, v9, v121, v148
  v_dot2_f32_bf16 v148, v10, v122, v148
  v_dot2_f32_bf16 v148, v11, v123, v148
  s_waitcnt vmcnt(4)
  s_cbranch_vccnz L_bz13
  s_waitcnt vmcnt(2)
  s_cbranch_scc1 L_bz13
  s_waitcnt vmcnt(1)
L_bz13:
  buffer_load_dwordx4 v[8:11], v1, s[40:43], s23 offen nt
  s_waitcnt lgkmcnt(0)
  s_sub_u32 s80, s82, s54
  s_sub_u32 s80, s80, 1007
  s_cmp_gt_i32 s80, 80
  s_cselect_b64 vcc, 1, 0
  s_cmp_gt_i32 s80, 0
  v_dot2_f32_bf16 v133, v12, v120, 0
  v_dot2_f32_bf16 v133, v13, v121, v133
  v_dot2_f32_bf16 v133, v14, v122, v133
  v_dot2_f32_bf16 v133, v15, v123, v133
  s_waitcnt vmcnt(4)
  s_cbranch_vccnz L_bz14
  s_waitcnt vmcnt(2)
  s_cbranch_scc1 L_bz14
  s_waitcnt vmcnt(1)
L_bz14:
  buffer_load_dwordx4 v[12:15], v1, s[40:43], s24 offen nt
  v_dot2_f32_bf16 v149, v16, v120, 0
  v_dot2_f32_bf16 v149, v17, v121, v149
  v_dot2_f32_bf16 v149, v18, v122, v149
  v_dot2_f32_bf16 v149, v19, v123, v149
  v_permlane16_swap_b32 v132, v148
  s_nop 1
  v_permlane16_swap_b32 v133, v149
  v_pk_add_f32 v[132:133], v[132:133], v[148:149]
  s_nop 1
  v_add_f32_dpp v132, v132, v132 quad_perm:[1,0,3,2] row_mask:0xf bank_mask:0xf
  v_add_f32_dpp v133, v133, v133 quad_perm:[1,0,3,2] row_mask:0xf bank_mask:0xf
  s_nop 0
  v_add_f32_dpp v132, v132, v132 quad_perm:[2,3,0,1] row_mask:0xf bank_mask:0xf
  v_add_f32_dpp v133, v133, v133 quad_perm:[2,3,0,1] row_mask:0xf bank_mask:0xf
  s_nop 0
  v_add_f32_dpp v132, v132, v132 row_half_mirror row_mask:0xf bank_mask:0xf
  v_add_f32_dpp v133, v133, v133 row_half_mirror row_mask:0xf bank_mask:0xf
  s_nop 0
  v_add_f32_dpp v132, v132, v132 row_mirror row_mask:0xf bank_mask:0xf
  v_add_f32_dpp v133, v133, v133 row_mirror row_mask:0xf bank_mask:0xf
  v_max_f32 v160, v132, v133
  v_dot2_f32_bf16 v134, v20, v120, 0
  v_dot2_f32_bf16 v134, v21, v121, v134
  v_dot2_f32_bf16 v134, v22, v122, v134
  v_dot2_f32_bf16 v134, v23, v123, v134
  v_dot2_f32_bf16 v148, v24, v120, 0
  v_dot2_f32_bf16 v148, v25, v121, v148
  v_dot2_f32_bf16 v148, v26, v122, v148
  v_dot2_f32_bf16 v148, v27, v123, v148
  s_waitcnt vmcnt(4)
  s_cbranch_vccnz L_bz15
  s_waitcnt vmcnt(2)
  s_cbranch_scc1 L_bz15
  s_waitcnt vmcnt(1)
L_bz15:
  buffer_load_dwordx4 v[16:19], v1, s[40:43], s25 offen nt
  v_dot2_f32_bf16 v135, v28, v120, 0
  v_dot2_f32_bf16 v135, v29, v121, v135
  v_dot2_f32_bf16 v135, v30, v122, v135
  v_dot2_f32_bf16 v135, v31, v123, v135
  v_dot2_f32_bf16 v149, v32, v120, 0
  v_dot2_f32_bf16 v149, v33, v121, v149
  v_dot2_f32_bf16 v149, v34, v122, v149
  v_dot2_f32_bf16 v149, v35, v123, v149
  v_permlane16_swap_b32 v134, v148
  s_nop 1
  v_permlane16_swap_b32 v135, v149
  v_pk_add_f32 v[134:135], v[134:135], v[148:149]
  s_nop 1
  v_add_f32_dpp v134, v134, v134 quad_perm:[1,0,3,2] row_mask:0xf bank_mask:0xf
  v_add_f32_dpp v135, v135, v135 quad_perm:[1,0,3,2] row_mask:0xf bank_mask:0xf
  s_nop 0
  v_add_f32_dpp v134, v134, v134 quad_perm:[2,3,0,1] row_mask:0xf bank_mask:0xf
  v_add_f32_dpp v135, v135, v135 quad_perm:[2,3,0,1] row_mask:0xf bank_mask:0xf
  s_nop 0
  v_add_f32_dpp v134, v134, v134 row_half_mirror row_mask:0xf bank_mask:0xf
  v_add_f32_dpp v135, v135, v135 row_half_mirror row_mask:0xf bank_mask:0xf
  s_nop 0
  v_add_f32_dpp v134, v134, v134 row_mirror row_mask:0xf bank_mask:0xf
  v_add_f32_dpp v135, v135, v135 row_mirror row_mask:0xf bank_mask:0xf
  v_max3_f32 v160, v134, v135, v160
  v_dot2_f32_bf16 v136, v36, v120, 0
  v_dot2_f32_bf16 v136, v37, v121, v136
  v_dot2_f32_bf16 v136, v38, v122, v136
  v_dot2_f32_bf16 v136, v39, v123, v136
  s_waitcnt vmcnt(4)
  s_cbranch_vccnz L_bz16
  s_waitcnt vmcnt(2)
  s_cbranch_scc1 L_bz16
  s_waitcnt vmcnt(1)
L_bz16:
  buffer_load_dwordx4 v[20:23], v1, s[44:47], s60 offen nt
  s_memrealtime s[82:83]
  v_dot2_f32_bf16 v148, v40, v120, 0
  v_dot2_f32_bf16 v148, v41, v121, v148
  v_dot2_f32_bf16 v148, v42, v122, v148
  v_dot2_f32_bf16 v148, v43, v123, v148
  v_dot2_f32_bf16 v137, v44, v120, 0
  v_dot2_f32_bf16 v137, v45, v121, v137
  v_dot2_f32_bf16 v137, v46, v122, v137
  v_dot2_f32_bf16 v137, v47, v123, v137
  v_dot2_f32_bf16 v149, v48, v120, 0
  v_dot2_f32_bf16 v149, v49, v121, v149
  v_dot2_f32_bf16 v149, v50, v122, v149
  v_dot2_f32_bf16 v149, v51, v123, v149
  s_waitcnt vmcnt(4)
  s_cbranch_vccnz L_bz17
  s_waitcnt vmcnt(2)
  s_cbranch_scc1 L_bz17
  s_waitcnt vmcnt(1)
L_bz17:
  buffer_load_dwordx4 v[24:27], v1, s[44:47], s61 offen nt
  s_waitcnt lgkmcnt(0)
  s_sub_u32 s80, s82, s54
  s_sub_u32 s80, s80, 1114
  s_cmp_gt_i32 s80, 80
  s_cselect_b64 vcc, 1, 0
  s_cmp_gt_i32 s80, 0
  v_permlane16_swap_b32 v136, v148
  v_permlane16_swap_b32 v137, v149
  v_pk_add_f32 v[136:137], v[136:137], v[148:149]
  s_nop 1
  v_add_f32_dpp v136, v136, v136 quad_perm:[1,0,3,2] row_mask:0xf bank_mask:0xf
  v_add_f32_dpp v137, v137, v137 quad_perm:[1,0,3,2] row_mask:0xf bank_mask:0xf
  s_nop 0
  v_add_f32_dpp v136, v136, v136 quad_perm:[2,3,0,1] row_mask:0xf bank_mask:0xf
  v_add_f32_dpp v137, v137, v137 quad_perm:[2,3,0,1] row_mask:0xf bank_mask:0xf
  s_nop 0
  v_add_f32_dpp v136, v136, v136 row_half_mirror row_mask:0xf bank_mask:0xf
  v_add_f32_dpp v137, v137, v137 row_half_mirror row_mask:0xf bank_mask:0xf
  s_nop 0
  v_add_f32_dpp v136, v136, v136 row_mirror row_mask:0xf bank_mask:0xf
  v_add_f32_dpp v137, v137, v137 row_mirror row_mask:0xf bank_mask:0xf
  v_max3_f32 v160, v136, v137, v160
  v_dot2_f32_bf16 v138, v52, v120, 0
  v_dot2_f32_bf16 v138, v53, v121, v138
  v_dot2_f32_bf16 v138, v54, v122, v138
  v_dot2_f32_bf16 v138, v55, v123, v138
  v_dot2_f32_bf16 v148, v56, v120, 0
  v_dot2_f32_bf16 v148, v57, v121, v148
  v_dot2_f32_bf16 v148, v58, v122, v148
  v_dot2_f32_bf16 v148, v59, v123, v148
  v_dot2_f32_bf16 v139, v60, v120, 0
  v_dot2_f32_bf16 v139, v61, v121, v139
  v_dot2_f32_bf16 v139, v62, v122, v139
  v_dot2_f32_bf16 v139, v63, v123, v139
  s_waitcnt vmcnt(4)
  s_cbranch_vccnz L_bz18
  s_waitcnt vmcnt(2)
  s_cbranch_scc1 L_bz18
  s_waitcnt vmcnt(1)
L_bz18:
  buffer_load_dwordx4 v[28:31], v1, s[44:47], s68 offen nt
  v_dot2_f32_bf16 v149, v64, v120, 0
  v_dot2_f32_bf16 v149, v65, v121, v149
  v_dot2_f32_bf16 v149, v66, v122, v149
  v_dot2_f32_bf16 v149, v67, v123, v149
  v_permlane16_swap_b32 v138, v148
  s_nop 1
  v_permlane16_swap_b32 v139, v149
  v_pk_add_f32 v[138:139], v[138:139], v[148:149]
  s_nop 1
  v_add_f32_dpp v138, v138, v138 quad_perm:[1,0,3,2] row_mask:0xf bank_mask:0xf
  v_add_f32_dpp v139, v139, v139 quad_perm:[1,0,3,2] row_mask:0xf bank_mask:0xf
  s_nop 0
  v_add_f32_dpp v138, v138, v138 quad_perm:[2,3,0,1] row_mask:0xf bank_mask:0xf
  v_add_f32_dpp v139, v139, v139 quad_perm:[2,3,0,1] row_mask:0xf bank_mask:0xf
  s_nop 0
  v_add_f32_dpp v138, v138, v138 row_half_mirror row_mask:0xf bank_mask:0xf
  v_add_f32_dpp v139, v139, v139 row_half_mirror row_mask:0xf bank_mask:0xf
  s_nop 0
  v_add_f32_dpp v138, v138, v138 row_mirror row_mask:0xf bank_mask:0xf
  v_add_f32_dpp v139, v139, v139 row_mirror row_mask:0xf bank_mask:0xf
  v_max3_f32 v160, v138, v139, v160
  v_mov_b32 v148, v160
  s_nop 1
  v_permlane16_swap_b32 v160, v148
  v_max_f32 v160, v160, v148
  v_mov_b32 v148, v160
  s_nop 1
  v_permlane32_swap_b32 v160, v148
  v_max_f32 v160, v160, v148
  v_mul_f32 v152, s67, v160
  v_fma_f32 v132, v132, s67, -v152
  v_fma_f32 v133, v133, s67, -v152
  v_fma_f32 v134, v134, s67, -v152
  v_fma_f32 v135, v135, s67, -v152
  v_fma_f32 v136, v136, s67, -v152
  v_fma_f32 v137, v137, s67, -v152
  v_fma_f32 v138, v138, s67, -v152
  v_fma_f32 v139, v139, s67, -v152
  v_exp_f32 v132, v132
  v_exp_f32 v133, v133
  v_exp_f32 v134, v134
  v_exp_f32 v135, v135
  v_exp_f32 v136, v136
  v_exp_f32 v137, v137
  v_exp_f32 v138, v138
  v_exp_f32 v139, v139
  v_pk_add_f32 v[148:149], v[132:133], v[134:135]
  v_pk_add_f32 v[156:157], v[136:137], v[138:139]
  v_pk_add_f32 v[148:149], v[148:149], v[156:157]
  v_mov_b64 v[156:157], v[132:133]
  s_nop 1
  v_permlane16_swap_b32 v132, v156
  v_permlane16_swap_b32 v133, v157
  v_permlane16_swap_b32 v148, v149
  v_add_f32 v148, v148, v149
  v_mov_b32 v149, v148
  s_nop 1
  v_permlane16_swap_b32 v148, v149
  v_add_f32 v148, v148, v149
  v_mov_b32 v149, v148
  s_nop 1
  v_permlane32_swap_b32 v148, v149
  v_add_f32 v153, v148, v149
  s_mov_b64 exec, 1
  ds_write_b64 v164, v[152:153] offset:4352
  s_mov_b64 exec, -1
  v_lshlrev_b32 v148, 16, v68
  v_and_b32 v149, s66, v68
  v_lshlrev_b32 v150, 16, v69
  v_and_b32 v151, s66, v69
  v_lshlrev_b32 v152, 16, v70
  v_and_b32 v153, s66, v70
  v_lshlrev_b32 v154, 16, v71
  v_and_b32 v155, s66, v71
  v_pk_mul_f32 v[116:117], v[148:149], v[132:133] op_sel_hi:[1,0]
  v_pk_mul_f32 v[118:119], v[150:151], v[132:133] op_sel_hi:[1,0]
  v_pk_mul_f32 v[120:121], v[152:153], v[132:133] op_sel_hi:[1,0]
  v_pk_mul_f32 v[122:123], v[154:155], v[132:133] op_sel_hi:[1,0]
  v_lshlrev_b32 v148, 16, v72
  v_and_b32 v149, s66, v72
  v_lshlrev_b32 v150, 16, v73
  v_and_b32 v151, s66, v73
  v_lshlrev_b32 v152, 16, v74
  v_and_b32 v153, s66, v74
  v_lshlrev_b32 v154, 16, v75
  v_and_b32 v155, s66, v75
  s_waitcnt vmcnt(4)
  s_cbranch_vccnz L_bz19
  s_waitcnt vmcnt(2)
  s_cbranch_scc1 L_bz19
  s_waitcnt vmcnt(1)
L_bz19:
  buffer_load_dwordx4 v[32:35], v1, s[44:47], s69 offen nt
  v_pk_fma_f32 v[116:117], v[148:149], v[156:157], v[116:117] op_sel_hi:[1,0,1]
  v_pk_fma_f32 v[118:119], v[150:151], v[156:157], v[118:119] op_sel_hi:[1,0,1]
  v_pk_fma_f32 v[120:121], v[152:153], v[156:157], v[120:121] op_sel_hi:[1,0,1]
  v_pk_fma_f32 v[122:123], v[154:155], v[156:157], v[122:123] op_sel_hi:[1,0,1]
  v_lshlrev_b32 v148, 16, v76
  v_and_b32 v149, s66, v76
  v_lshlrev_b32 v150, 16, v77
  v_and_b32 v151, s66, v77
  v_lshlrev_b32 v152, 16, v78
  v_and_b32 v153, s66, v78
  v_lshlrev_b32 v154, 16, v79
  v_and_b32 v155, s66, v79
  v_pk_fma_f32 v[116:117], v[148:149], v[132:133], v[116:117] op_sel:[0,1,0]
  v_pk_fma_f32 v[118:119], v[150:151], v[132:133], v[118:119] op_sel:[0,1,0]
  v_pk_fma_f32 v[120:121], v[152:153], v[132:133], v[120:121] op_sel:[0,1,0]
  v_pk_fma_f32 v[122:123], v[154:155], v[132:133], v[122:123] op_sel:[0,1,0]
  v_lshlrev_b32 v148, 16, v80
  v_and_b32 v149, s66, v80
  v_lshlrev_b32 v150, 16, v81
  v_and_b32 v151, s66, v81
  v_lshlrev_b32 v152, 16, v82
  v_and_b32 v153, s66, v82
  v_lshlrev_b32 v154, 16, v83
  v_and_b32 v155, s66, v83
  v_pk_fma_f32 v[116:117], v[148:149], v[156:157], v[116:117] op_sel:[0,1,0]
  v_pk_fma_f32 v[118:119], v[150:151], v[156:157], v[118:119] op_sel:[0,1,0]
  v_pk_fma_f32 v[120:121], v[152:153], v[156:157], v[120:121] op_sel:[0,1,0]
  v_pk_fma_f32 v[122:123], v[154:155], v[156:157], v[122:123] op_sel:[0,1,0]
  v_mov_b64 v[156:157], v[134:135]
  s_nop 1
  v_permlane16_swap_b32 v134, v156
  v_permlane16_swap_b32 v135, v157
  v_lshlrev_b32 v148, 16, v84
  v_and_b32 v149, s66, v84
  v_lshlrev_b32 v150, 16, v85
  v_and_b32 v151, s66, v85
  v_lshlrev_b32 v152, 16, v86
  v_and_b32 v153, s66, v86
  v_lshlrev_b32 v154, 16, v87
  v_and_b32 v155, s66, v87
  s_waitcnt vmcnt(4)
  s_cbranch_vccnz L_bz20
  s_waitcnt vmcnt(2)
  s_cbranch_scc1 L_bz20
  s_waitcnt vmcnt(1)
L_bz20:
  buffer_load_dwordx4 v[36:39], v1, s[44:47], s14 offen nt
  s_memrealtime s[82:83]
  v_pk_fma_f32 v[116:117], v[148:149], v[134:135], v[116:117] op_sel_hi:[1,0,1]
  v_pk_fma_f32 v[118:119], v[150:151], v[134:135], v[118:119] op_sel_hi:[1,0,1]
  v_pk_fma_f32 v[120:121], v[152:153], v[134:135], v[120:121] op_sel_hi:[1,0,1]
  v_pk_fma_f32 v[122:123], v[154:155], v[134:135], v[122:123] op_sel_hi:[1,0,1]
  v_lshlrev_b32 v148, 16, v88
  v_and_b32 v149, s66, v88
  v_lshlrev_b32 v150, 16, v89
  v_and_b32 v151, s66, v89
  v_lshlrev_b32 v152, 16, v90
  v_and_b32 v153, s66, v90
  v_lshlrev_b32 v154, 16, v91
  v_and_b32 v155, s66, v91
  v_pk_fma_f32 v[116:117], v[148:149], v[156:157], v[116:117] op_sel_hi:[1,0,1]
  v_pk_fma_f32 v[118:119], v[150:151], v[156:157], v[118:119] op_sel_hi:[1,0,1]
  v_pk_fma_f32 v[120:121], v[152:153], v[156:157], v[120:121] op_sel_hi:[1,0,1]
  v_pk_fma_f32 v[122:123], v[154:155], v[156:157], v[122:123] op_sel_hi:[1,0,1]
  v_lshlrev_b32 v148, 16, v92
  v_and_b32 v149, s66, v92
  v_lshlrev_b32 v150, 16, v93
  v_and_b32 v151, s66, v93
  v_lshlrev_b32 v152, 16, v94
  v_and_b32 v153, s66, v94
  v_lshlrev_b32 v154, 16, v95
  v_and_b32 v155, s66, v95
  v_pk_fma_f32 v[116:117], v[148:149], v[134:135], v[116:117] op_sel:[0,1,0]
  v_pk_fma_f32 v[118:119], v[150:151], v[134:135], v[118:119] op_sel:[0,1,0]
  v_pk_fma_f32 v[120:121], v[152:153], v[134:135], v[120:121] op_sel:[0,1,0]
  v_pk_fma_f32 v[122:123], v[154:155], v[134:135], v[122:123] op_sel:[0,1,0]
  v_lshlrev_b32 v148, 16, v96
  v_and_b32 v149, s66, v96
  v_lshlrev_b32 v150, 16, v97
  v_and_b32 v151, s66, v97
  v_lshlrev_b32 v152, 16, v98
  v_and_b32 v153, s66, v98
  v_lshlrev_b32 v154, 16, v99
  v_and_b32 v155, s66, v99
  s_waitcnt vmcnt(4)
  s_cbranch_vccnz L_bz21
  s_waitcnt vmcnt(2)
  s_cbranch_scc1 L_bz21
  s_waitcnt vmcnt(1)
L_bz21:
  buffer_load_dwordx4 v[40:43], v1, s[44:47], s15 offen nt
  s_waitcnt lgkmcnt(0)
  s_sub_u32 s80, s82, s54
  s_sub_u32 s80, s80, 1221
  s_cmp_gt_i32 s80, 80
  s_cselect_b64 vcc, 1, 0
  s_cmp_gt_i32 s80, 0
  v_pk_fma_f32 v[116:117], v[148:149], v[156:157], v[116:117] op_sel:[0,1,0]
  v_pk_fma_f32 v[118:119], v[150:151], v[156:157], v[118:119] op_sel:[0,1,0]
  v_pk_fma_f32 v[120:121], v[152:153], v[156:157], v[120:121] op_sel:[0,1,0]
  v_pk_fma_f32 v[122:123], v[154:155], v[156:157], v[122:123] op_sel:[0,1,0]
  v_mov_b64 v[156:157], v[136:137]
  s_nop 1
  v_permlane16_swap_b32 v136, v156
  v_permlane16_swap_b32 v137, v157
  v_lshlrev_b32 v148, 16, v100
  v_and_b32 v149, s66, v100
  v_lshlrev_b32 v150, 16, v101
  v_and_b32 v151, s66, v101
  v_lshlrev_b32 v152, 16, v102
  v_and_b32 v153, s66, v102
  v_lshlrev_b32 v154, 16, v103
  v_and_b32 v155, s66, v103
  v_pk_fma_f32 v[116:117], v[148:149], v[136:137], v[116:117] op_sel_hi:[1,0,1]
  v_pk_fma_f32 v[118:119], v[150:151], v[136:137], v[118:119] op_sel_hi:[1,0,1]
  v_pk_fma_f32 v[120:121], v[152:153], v[136:137], v[120:121] op_sel_hi:[1,0,1]
  v_pk_fma_f32 v[122:123], v[154:155], v[136:137], v[122:123] op_sel_hi:[1,0,1]
  v_lshlrev_b32 v148, 16, v104
  v_and_b32 v149, s66, v104
  v_lshlrev_b32 v150, 16, v105
  v_and_b32 v151, s66, v105
  v_lshlrev_b32 v152, 16, v106
  v_and_b32 v153, s66, v106
  v_lshlrev_b32 v154, 16, v107
  v_and_b32 v155, s66, v107
  v_pk_fma_f32 v[116:117], v[148:149], v[156:157], v[116:117] op_sel_hi:[1,0,1]
  v_pk_fma_f32 v[118:119], v[150:151], v[156:157], v[118:119] op_sel_hi:[1,0,1]
  v_pk_fma_f32 v[120:121], v[152:153], v[156:157], v[120:121] op_sel_hi:[1,0,1]
  v_pk_fma_f32 v[122:123], v[154:155], v[156:157], v[122:123] op_sel_hi:[1,0,1]
  v_lshlrev_b32 v148, 16, v108
  v_and_b32 v149, s66, v108
  v_lshlrev_b32 v150, 16, v109
  v_and_b32 v151, s66, v109
  v_lshlrev_b32 v152, 16, v110
  v_and_b32 v153, s66, v110
  v_lshlrev_b32 v154, 16, v111
  v_and_b32 v155, s66, v111
  s_waitcnt vmcnt(4)
  s_cbranch_vccnz L_bz22
  s_waitcnt vmcnt(2)
  s_cbranch_scc1 L_bz22
  s_waitcnt vmcnt(1)
L_bz22:
  buffer_load_dwordx4 v[44:47], v1, s[44:47], s16 offen nt
  v_pk_fma_f32 v[116:117], v[148:149], v[136:137], v[116:117] op_sel:[0,1,0]
  v_pk_fma_f32 v[118:119], v[150:151], v[136:137], v[118:119] op_sel:[0,1,0]
  v_pk_fma_f32 v[120:121], v[152:153], v[136:137], v[120:121] op_sel:[0,1,0]
  v_pk_fma_f32 v[122:123], v[154:155], v[136:137], v[122:123] op_sel:[0,1,0]
  v_lshlrev_b32 v148, 16, v112
  v_and_b32 v149, s66, v112
  v_lshlrev_b32 v150, 16, v113
  v_and_b32 v151, s66, v113
  v_lshlrev_b32 v152, 16, v114
  v_and_b32 v153, s66, v114
  v_lshlrev_b32 v154, 16, v115
  v_and_b32 v155, s66, v115
  v_pk_fma_f32 v[116:117], v[148:149], v[156:157], v[116:117] op_sel:[0,1,0]
  v_pk_fma_f32 v[118:119], v[150:151], v[156:157], v[118:119] op_sel:[0,1,0]
  v_pk_fma_f32 v[120:121], v[152:153], v[156:157], v[120:121] op_sel:[0,1,0]
  v_pk_fma_f32 v[122:123], v[154:155], v[156:157], v[122:123] op_sel:[0,1,0]
  v_mov_b64 v[156:157], v[138:139]
  s_nop 1
  v_permlane16_swap_b32 v138, v156
  v_permlane16_swap_b32 v139, v157
  v_lshlrev_b32 v148, 16, v4
  v_and_b32 v149, s66, v4
  v_lshlrev_b32 v150, 16, v5
  v_and_b32 v151, s66, v5
  v_lshlrev_b32 v152, 16, v6
  v_and_b32 v153, s66, v6
  v_lshlrev_b32 v154, 16, v7
  v_and_b32 v155, s66, v7
  v_pk_fma_f32 v[116:117], v[148:149], v[138:139], v[116:117] op_sel_hi:[1,0,1]
  v_pk_fma_f32 v[118:119], v[150:151], v[138:139], v[118:119] op_sel_hi:[1,0,1]
  v_pk_fma_f32 v[120:121], v[152:153], v[138:139], v[120:121] op_sel_hi:[1,0,1]
  v_pk_fma_f32 v[122:123], v[154:155], v[138:139], v[122:123] op_sel_hi:[1,0,1]
  v_lshlrev_b32 v148, 16, v8
  v_and_b32 v149, s66, v8
  v_lshlrev_b32 v150, 16, v9
  v_and_b32 v151, s66, v9
  v_lshlrev_b32 v152, 16, v10
  v_and_b32 v153, s66, v10
  v_lshlrev_b32 v154, 16, v11
  v_and_b32 v155, s66, v11
  s_waitcnt vmcnt(4)
  s_cbranch_vccnz L_bz23
  s_waitcnt vmcnt(2)
  s_cbranch_scc1 L_bz23
  s_waitcnt vmcnt(1)
L_bz23:
  buffer_load_dwordx4 v[48:51], v1, s[44:47], s17 offen nt
  v_pk_fma_f32 v[116:117], v[148:149], v[156:157], v[116:117] op_sel_hi:[1,0,1]
  v_pk_fma_f32 v[118:119], v[150:151], v[156:157], v[118:119] op_sel_hi:[1,0,1]
  v_pk_fma_f32 v[120:121], v[152:153], v[156:157], v[120:121] op_sel_hi:[1,0,1]
  v_pk_fma_f32 v[122:123], v[154:155], v[156:157], v[122:123] op_sel_hi:[1,0,1]
  v_lshlrev_b32 v148, 16, v12
  v_and_b32 v149, s66, v12
  v_lshlrev_b32 v150, 16, v13
  v_and_b32 v151, s66, v13
  v_lshlrev_b32 v152, 16, v14
  v_and_b32 v153, s66, v14
  v_lshlrev_b32 v154, 16, v15
  v_and_b32 v155, s66, v15
  v_pk_fma_f32 v[116:117], v[148:149], v[138:139], v[116:117] op_sel:[0,1,0]
  v_pk_fma_f32 v[118:119], v[150:151], v[138:139], v[118:119] op_sel:[0,1,0]
  v_pk_fma_f32 v[120:121], v[152:153], v[138:139], v[120:121] op_sel:[0,1,0]
  v_pk_fma_f32 v[122:123], v[154:155], v[138:139], v[122:123] op_sel:[0,1,0]
  v_lshlrev_b32 v148, 16, v16
  v_and_b32 v149, s66, v16
  v_lshlrev_b32 v150, 16, v17
  v_and_b32 v151, s66, v17
  v_lshlrev_b32 v152, 16, v18
  v_and_b32 v153, s66, v18
  v_lshlrev_b32 v154, 16, v19
  v_and_b32 v155, s66, v19
  v_pk_fma_f32 v[116:117], v[148:149], v[156:157], v[116:117] op_sel:[0,1,0]
  v_pk_fma_f32 v[118:119], v[150:151], v[156:157], v[118:119] op_sel:[0,1,0]
  v_pk_fma_f32 v[120:121], v[152:153], v[156:157], v[120:121] op_sel:[0,1,0]
  v_pk_fma_f32 v[122:123], v[154:155], v[156:157], v[122:123] op_sel:[0,1,0]
  s_nop 0
  v_permlane32_swap_b32 v116, v120
  v_permlane32_swap_b32 v117, v121
  v_permlane32_swap_b32 v118, v122
  v_permlane32_swap_b32 v119, v123
  v_pk_add_f32 v[116:117], v[116:117], v[120:121]
  v_pk_add_f32 v[118:119], v[118:119], v[122:123]
  ds_write_b128 v163, v[116:119] offset:5120
  s_mov_b64 exec, 1
  ds_add_u32 v162, v3 offset:4112
  s_mov_b64 exec, -1
  s_mov_b32 s65, 524288
L_lw24:
  ds_read_b64 v[148:149], v162 offset:4104
  s_waitcnt lgkmcnt(0)
  v_and_b32 v148, v148, v149
  v_cmp_ne_u32 vcc, 1, v148
  s_cbranch_vccz L_lwok24
  s_sleep 1
  s_sub_u32 s65, s65, 1
  s_cmp_lg_u32 s65, 0
  s_cbranch_scc1 L_lw24
L_lwok24:
  ds_read_b128 v[120:123], v2 offset:1024
  ds_read_b128 v[128:131], v2 offset:1536
  s_waitcnt lgkmcnt(0)
  s_cmp_gt_i32 s80, 80
  s_cselect_b64 vcc, 1, 0
  s_cmp_gt_i32 s80, 0
  v_dot2_f32_bf16 v132, v20, v120, 0
  v_dot2_f32_bf16 v140, v20, v128, 0
  v_dot2_f32_bf16 v132, v21, v121, v132
  v_dot2_f32_bf16 v140, v21, v129, v140
  v_dot2_f32_bf16 v132, v22, v122, v132
  v_dot2_f32_bf16 v140, v22, v130, v140
  v_dot2_f32_bf16 v132, v23, v123, v132
  v_dot2_f32_bf16 v140, v23, v131, v140
  s_waitcnt vmcnt(4)
  s_cbranch_vccnz L_bz25
  s_waitcnt vmcnt(2)
  s_cbranch_scc1 L_bz25
  s_waitcnt vmcnt(1)
L_bz25:
  buffer_load_dwordx4 v[52:55], v1, s[44:47], s18 offen nt
  s_memrealtime s[82:83]
  v_dot2_f32_bf16 v148, v24, v120, 0
  v_dot2_f32_bf16 v150, v24, v128, 0
  v_dot2_f32_bf16 v148, v25, v121, v148
  v_dot2_f32_bf16 v150, v25, v129, v150
  v_dot2_f32_bf16 v148, v26, v122, v148
  v_dot2_f32_bf16 v150, v26, v130, v150
  v_dot2_f32_bf16 v148, v27, v123, v148
  v_dot2_f32_bf16 v150, v27, v131, v150
  s_waitcnt vmcnt(4)
  s_cbranch_vccnz L_bz26
  s_waitcnt vmcnt(2)
  s_cbranch_scc1 L_bz26
  s_waitcnt vmcnt(1)
L_bz26:
  buffer_load_dwordx4 v[56:59], v1, s[44:47], s19 offen nt
  s_waitcnt lgkmcnt(0)
  s_sub_u32 s80, s82, s54
  s_sub_u32 s80, s80, 1328
  s_cmp_gt_i32 s80, 80
  s_cselect_b64 vcc, 1, 0
  s_cmp_gt_i32 s80, 0
  v_dot2_f32_bf16 v133, v28, v120, 0
  v_dot2_f32_bf16 v141, v28, v128, 0
  v_dot2_f32_bf16 v133, v29, v121, v133
  v_dot2_f32_bf16 v141, v29, v129, v141
  v_dot2_f32_bf16 v133, v30, v122, v133
  v_dot2_f32_bf16 v141, v30, v130, v141
  v_dot2_f32_bf16 v133, v31, v123, v133
  v_dot2_f32_bf16 v141, v31, v131, v141
  s_waitcnt vmcnt(4)
  s_cbranch_vccnz L_bz27
  s_waitcnt vmcnt(2)
  s_cbranch_scc1 L_bz27
  s_waitcnt vmcnt(1)
L_bz27:
  buffer_load_dwordx4 v[60:63], v1, s[44:47], s20 offen nt
  v_dot2_f32_bf16 v149, v32, v120, 0
  v_dot2_f32_bf16 v151, v32, v128, 0
  v_dot2_f32_bf16 v149, v33, v121, v149
  v_dot2_f32_bf16 v151, v33, v129, v151
  v_dot2_f32_bf16 v149, v34, v122, v149
  v_dot2_f32_bf16 v151, v34, v130, v151
  v_dot2_f32_bf16 v149, v35, v123, v149
  v_dot2_f32_bf16 v151, v35, v131, v151
  s_waitcnt vmcnt(4)
  s_cbranch_vccnz L_bz28
  s_waitcnt vmcnt(2)
  s_cbranch_scc1 L_bz28
  s_waitcnt vmcnt(1)
L_bz28:
  buffer_load_dwordx4 v[64:67], v1, s[44:47], s21 offen nt
  v_permlane16_swap_b32 v132, v148
  v_permlane16_swap_b32 v133, v149
  v_permlane16_swap_b32 v140, v150
  v_permlane16_swap_b32 v141, v151
  v_pk_add_f32 v[132:133], v[132:133], v[148:149]
  v_pk_add_f32 v[140:141], v[140:141], v[150:151]
  s_nop 0
  v_add_f32_dpp v132, v132, v132 quad_perm:[1,0,3,2] row_mask:0xf bank_mask:0xf
  v_add_f32_dpp v133, v133, v133 quad_perm:[1,0,3,2] row_mask:0xf bank_mask:0xf
  v_add_f32_dpp v140, v140, v140 quad_perm:[1,0,3,2] row_mask:0xf bank_mask:0xf
  v_add_f32_dpp v141, v141, v141 quad_perm:[1,0,3,2] row_mask:0xf bank_mask:0xf
  v_add_f32_dpp v132, v132, v132 quad_perm:[2,3,0,1] row_mask:0xf bank_mask:0xf
  v_add_f32_dpp v133, v133, v133 quad_perm:[2,3,0,1] row_mask:0xf bank_mask:0xf
  v_add_f32_dpp v140, v140, v140 quad_perm:[2,3,0,1] row_mask:0xf bank_mask:0xf
  v_add_f32_dpp v141, v141, v141 quad_perm:[2,3,0,1] row_mask:0xf bank_mask:0xf
  v_add_f32_dpp v132, v132, v132 row_half_mirror row_mask:0xf bank_mask:0xf
  v_add_f32_dpp v133, v133, v133 row_half_mirror row_mask:0xf bank_mask:0xf
  v_add_f32_dpp v140, v140, v140 row_half_mirror row_mask:0xf bank_mask:0xf
  v_add_f32_dpp v141, v141, v141 row_half_mirror row_mask:0xf bank_mask:0xf
  v_add_f32_dpp v132, v132, v132 row_mirror row_mask:0xf bank_mask:0xf
  v_add_f32_dpp v133, v133, v133 row_mirror row_mask:0xf bank_mask:0xf
  v_add_f32_dpp v140, v140, v140 row_mirror row_mask:0xf bank_mask:0xf
  v_add_f32_dpp v141, v141, v141 row_mirror row_mask:0xf bank_mask:0xf
  v_max_f32 v160, v132, v133
  v_max_f32 v161, v140, v141
  v_dot2_f32_bf16 v134, v36, v120, 0
  v_dot2_f32_bf16 v142, v36, v128, 0
  v_dot2_f32_bf16 v134, v37, v121, v134
  v_dot2_f32_bf16 v142, v37, v129, v142
  v_dot2_f32_bf16 v134, v38, v122, v134
  v_dot2_f32_bf16 v142, v38, v130, v142
  v_dot2_f32_bf16 v134, v39, v123, v134
  v_dot2_f32_bf16 v142, v39, v131, v142
  s_waitcnt vmcnt(4)
  s_cbranch_vccnz L_bz29
  s_waitcnt vmcnt(2)
  s_cbranch_scc1 L_bz29
  s_waitcnt vmcnt(1)
L_bz29:
  buffer_load_dwordx4 v[68:71], v1, s[44:47], s22 offen nt
  s_memrealtime s[82:83]
  v_dot2_f32_bf16 v148, v40, v120, 0
  v_dot2_f32_bf16 v150, v40, v128, 0
  v_dot2_f32_bf16 v148, v41, v121, v148
  v_dot2_f32_bf16 v150, v41, v129, v150
  v_dot2_f32_bf16 v148, v42, v122, v148
  v_dot2_f32_bf16 v150, v42, v130, v150
  v_dot2_f32_bf16 v148, v43, v123, v148
  v_dot2_f32_bf16 v150, v43, v131, v150
  s_waitcnt vmcnt(4)
  s_cbranch_vccnz L_bz30
  s_waitcnt vmcnt(2)
  s_cbranch_scc1 L_bz30
  s_waitcnt vmcnt(1)
L_bz30:
  buffer_load_dwordx4 v[72:75], v1, s[44:47], s23 offen nt
  s_waitcnt lgkmcnt(0)
  s_sub_u32 s80, s82, s54
  s_sub_u32 s80, s80, 1434
  s_cmp_gt_i32 s80, 80
  s_cselect_b64 vcc, 1, 0
  s_cmp_gt_i32 s80, 0
  v_dot2_f32_bf16 v135, v44, v120, 0
  v_dot2_f32_bf16 v143, v44, v128, 0
  v_dot2_f32_bf16 v135, v45, v121, v135
  v_dot2_f32_bf16 v143, v45, v129, v143
  v_dot2_f32_bf16 v135, v46, v122, v135
  v_dot2_f32_bf16 v143, v46, v130, v143
  v_dot2_f32_bf16 v135, v47, v123, v135
  v_dot2_f32_bf16 v143, v47, v131, v143
  s_waitcnt vmcnt(4)
  s_cbranch_vccnz L_bz31
  s_waitcnt vmcnt(2)
  s_cbranch_scc1 L_bz31
  s_waitcnt vmcnt(1)
L_bz31:
  buffer_load_dwordx4 v[76:79], v1, s[44:47], s24 offen nt
  v_dot2_f32_bf16 v149, v48, v120, 0
  v_dot2_f32_bf16 v151, v48, v128, 0
  v_dot2_f32_bf16 v149, v49, v121, v149
  v_dot2_f32_bf16 v151, v49, v129, v151
  v_dot2_f32_bf16 v149, v50, v122, v149
  v_dot2_f32_bf16 v151, v50, v130, v151
  v_dot2_f32_bf16 v149, v51, v123, v149
  v_dot2_f32_bf16 v151, v51, v131, v151
  s_waitcnt vmcnt(4)
  s_cbranch_vccnz L_bz32
  s_waitcnt vmcnt(2)
  s_cbranch_scc1 L_bz32
  s_waitcnt vmcnt(1)
L_bz32:
  buffer_load_dwordx4 v[80:83], v1, s[44:47], s25 offen nt
  v_permlane16_swap_b32 v134, v148
  v_permlane16_swap_b32 v135, v149
  v_permlane16_swap_b32 v142, v150
  v_permlane16_swap_b32 v143, v151
  v_pk_add_f32 v[134:135], v[134:135], v[148:149]
  v_pk_add_f32 v[142:143], v[142:143], v[150:151]
  s_nop 0
  v_add_f32_dpp v134, v134, v134 quad_perm:[1,0,3,2] row_mask:0xf bank_mask:0xf
  v_add_f32_dpp v135, v135, v135 quad_perm:[1,0,3,2] row_mask:0xf bank_mask:0xf
  v_add_f32_dpp v142, v142, v142 quad_perm:[1,0,3,2] row_mask:0xf bank_mask:0xf
  v_add_f32_dpp v143, v143, v143 quad_perm:[1,0,3,2] row_mask:0xf bank_mask:0xf
  v_add_f32_dpp v134, v134, v134 quad_perm:[2,3,0,1] row_mask:0xf bank_mask:0xf
  v_add_f32_dpp v135, v135, v135 quad_perm:[2,3,0,1] row_mask:0xf bank_mask:0xf
  v_add_f32_dpp v142, v142, v142 quad_perm:[2,3,0,1] row_mask:0xf bank_mask:0xf
  v_add_f32_dpp v143, v143, v143 quad_perm:[2,3,0,1] row_mask:0xf bank_mask:0xf
  v_add_f32_dpp v134, v134, v134 row_half_mirror row_mask:0xf bank_mask:0xf
  v_add_f32_dpp v135, v135, v135 row_half_mirror row_mask:0xf bank_mask:0xf
  v_add_f32_dpp v142, v142, v142 row_half_mirror row_mask:0xf bank_mask:0xf
  v_add_f32_dpp v143, v143, v143 row_half_mirror row_mask:0xf bank_mask:0xf
  v_add_f32_dpp v134, v134, v134 row_mirror row_mask:0xf bank_mask:0xf
  v_add_f32_dpp v135, v135, v135 row_mirror row_mask:0xf bank_mask:0xf
  v_add_f32_dpp v142, v142, v142 row_mirror row_mask:0xf bank_mask:0xf
  v_add_f32_dpp v143, v143, v143 row_mirror row_mask:0xf bank_mask:0xf
  v_max3_f32 v160, v134, v135, v160
  v_max3_f32 v161, v142, v143, v161
  v_dot2_f32_bf16 v136, v52, v120, 0
  v_dot2_f32_bf16 v144, v52, v128, 0
  v_dot2_f32_bf16 v136, v53, v121, v136
  v_dot2_f32_bf16 v144, v53, v129, v144
  v_dot2_f32_bf16 v136, v54, v122, v136
  v_dot2_f32_bf16 v144, v54, v130, v144
  v_dot2_f32_bf16 v136, v55, v123, v136
  v_dot2_f32_bf16 v144, v55, v131, v144
  s_waitcnt vmcnt(4)
  s_cbranch_vccnz L_bz33
  s_waitcnt vmcnt(2)
  s_cbranch_scc1 L_bz33
  s_waitcnt vmcnt(1)
L_bz33:
  buffer_load_dwordx4 v[84:87], v1, s[48:51], s60 offen nt
  s_memrealtime s[82:83]
  v_dot2_f32_bf16 v148, v56, v120, 0
  v_dot2_f32_bf16 v150, v56, v128, 0
  v_dot2_f32_bf16 v148, v57, v121, v148
  v_dot2_f32_bf16 v150, v57, v129, v150
  v_dot2_f32_bf16 v148, v58, v122, v148
  v_dot2_f32_bf16 v150, v58, v130, v150
  v_dot2_f32_bf16 v148, v59, v123, v148
  v_dot2_f32_bf16 v150, v59, v131, v150
  s_waitcnt vmcnt(4)
  s_cbranch_vccnz L_bz34
  s_waitcnt vmcnt(2)
  s_cbranch_scc1 L_bz34
  s_waitcnt vmcnt(1)
L_bz34:
  buffer_load_dwordx4 v[88:91], v1, s[48:51], s61 offen nt
  s_waitcnt lgkmcnt(0)
  s_sub_u32 s80, s82, s54
  s_sub_u32 s80, s80, 1541
  s_cmp_gt_i32 s80, 80
  s_cselect_b64 vcc, 1, 0
  s_cmp_gt_i32 s80, 0
  v_dot2_f32_bf16 v137, v60, v120, 0
  v_dot2_f32_bf16 v145, v60, v128, 0
  v_dot2_f32_bf16 v137, v61, v121, v137
  v_dot2_f32_bf16 v145, v61, v129, v145
  v_dot2_f32_bf16 v137, v62, v122, v137
  v_dot2_f32_bf16 v145, v62, v130, v145
  v_dot2_f32_bf16 v137, v63, v123, v137
  v_dot2_f32_bf16 v145, v63, v131, v145
  s_waitcnt vmcnt(4)
  s_cbranch_vccnz L_bz35
  s_waitcnt vmcnt(2)
  s_cbranch_scc1 L_bz35
  s_waitcnt vmcnt(1)
L_bz35:
  buffer_load_dwordx4 v[92:95], v1, s[48:51], s68 offen nt
  v_dot2_f32_bf16 v149, v64, v120, 0
  v_dot2_f32_bf16 v151, v64, v128, 0
  v_dot2_f32_bf16 v149, v65, v121, v149
  v_dot2_f32_bf16 v151, v65, v129, v151
  v_dot2_f32_bf16 v149, v66, v122, v149
  v_dot2_f32_bf16 v151, v66, v130, v151
  v_dot2_f32_bf16 v149, v67, v123, v149
  v_dot2_f32_bf16 v151, v67, v131, v151
  s_waitcnt vmcnt(4)
  s_cbranch_vccnz L_bz36
  s_waitcnt vmcnt(2)
  s_cbranch_scc1 L_bz36
  s_waitcnt vmcnt(1)
L_bz36:
  buffer_load_dwordx4 v[96:99], v1, s[48:51], s69 offen nt
  v_permlane16_swap_b32 v136, v148
  v_permlane16_swap_b32 v137, v149
  v_permlane16_swap_b32 v144, v150
  v_permlane16_swap_b32 v145, v151
  v_pk_add_f32 v[136:137], v[136:137], v[148:149]
  v_pk_add_f32 v[144:145], v[144:145], v[150:151]
  s_nop 0
  v_add_f32_dpp v136, v136, v136 quad_perm:[1,0,3,2] row_mask:0xf bank_mask:0xf
  v_add_f32_dpp v137, v137, v137 quad_perm:[1,0,3,2] row_mask:0xf bank_mask:0xf
  v_add_f32_dpp v144, v144, v144 quad_perm:[1,0,3,2] row_mask:0xf bank_mask:0xf
  v_add_f32_dpp v145, v145, v145 quad_perm:[1,0,3,2] row_mask:0xf bank_mask:0xf
  v_add_f32_dpp v136, v136, v136 quad_perm:[2,3,0,1] row_mask:0xf bank_mask:0xf
  v_add_f32_dpp v137, v137, v137 quad_perm:[2,3,0,1] row_mask:0xf bank_mask:0xf
  v_add_f32_dpp v144, v144, v144 quad_perm:[2,3,0,1] row_mask:0xf bank_mask:0xf
  v_add_f32_dpp v145, v145, v145 quad_perm:[2,3,0,1] row_mask:0xf bank_mask:0xf
  v_add_f32_dpp v136, v136, v136 row_half_mirror row_mask:0xf bank_mask:0xf
  v_add_f32_dpp v137, v137, v137 row_half_mirror row_mask:0xf bank_mask:0xf
  v_add_f32_dpp v144, v144, v144 row_half_mirror row_mask:0xf bank_mask:0xf
  v_add_f32_dpp v145, v145, v145 row_half_mirror row_mask:0xf bank_mask:0xf
  v_add_f32_dpp v136, v136, v136 row_mirror row_mask:0xf bank_mask:0xf
  v_add_f32_dpp v137, v137, v137 row_mirror row_mask:0xf bank_mask:0xf
  v_add_f32_dpp v144, v144, v144 row_mirror row_mask:0xf bank_mask:0xf
  v_add_f32_dpp v145, v145, v145 row_mirror row_mask:0xf bank_mask:0xf
  v_max3_f32 v160, v136, v137, v160
  v_max3_f32 v161, v144, v145, v161
  v_dot2_f32_bf16 v138, v68, v120, 0
  v_dot2_f32_bf16 v146, v68, v128, 0
  v_dot2_f32_bf16 v138, v69, v121, v138
  v_dot2_f32_bf16 v146, v69, v129, v146
  v_dot2_f32_bf16 v138, v70, v122, v138
  v_dot2_f32_bf16 v146, v70, v130, v146
  v_dot2_f32_bf16 v138, v71, v123, v138
  v_dot2_f32_bf16 v146, v71, v131, v146
  s_waitcnt vmcnt(4)
  s_cbranch_vccnz L_bz37
  s_waitcnt vmcnt(2)
  s_cbranch_scc1 L_bz37
  s_waitcnt vmcnt(1)
L_bz37:
  buffer_load_dwordx4 v[100:103], v1, s[48:51], s14 offen nt
  s_memrealtime s[82:83]
  v_dot2_f32_bf16 v148, v72, v120, 0
  v_dot2_f32_bf16 v150, v72, v128, 0
  v_dot2_f32_bf16 v148, v73, v121, v148
  v_dot2_f32_bf16 v150, v73, v129, v150
  v_dot2_f32_bf16 v148, v74, v122, v148
  v_dot2_f32_bf16 v150, v74, v130, v150
  v_dot2_f32_bf16 v148, v75, v123, v148
  v_dot2_f32_bf16 v150, v75, v131, v150
  s_waitcnt vmcnt(4)
  s_cbranch_vccnz L_bz38
  s_waitcnt vmcnt(2)
  s_cbranch_scc1 L_bz38
  s_waitcnt vmcnt(1)
L_bz38:
  buffer_load_dwordx4 v[104:107], v1, s[48:51], s15 offen nt
  s_waitcnt lgkmcnt(0)
  s_sub_u32 s80, s82, s54
  s_sub_u32 s80, s80, 1648
  s_cmp_gt_i32 s80, 80
  s_cselect_b64 vcc, 1, 0
  s_cmp_gt_i32 s80, 0
  v_dot2_f32_bf16 v139, v76, v120, 0
  v_dot2_f32_bf16 v147, v76, v128, 0
  v_dot2_f32_bf16 v139, v77, v121, v139
  v_dot2_f32_bf16 v147, v77, v129, v147
  v_dot2_f32_bf16 v139, v78, v122, v139
  v_dot2_f32_bf16 v147, v78, v130, v147
  v_dot2_f32_bf16 v139, v79, v123, v139
  v_dot2_f32_bf16 v147, v79, v131, v147
  s_waitcnt vmcnt(4)
  s_cbranch_vccnz L_bz39
  s_waitcnt vmcnt(2)
  s_cbranch_scc1 L_bz39
  s_waitcnt vmcnt(1)
L_bz39:
  buffer_load_dwordx4 v[108:111], v1, s[48:51], s16 offen nt
  v_dot2_f32_bf16 v149, v80, v120, 0
  v_dot2_f32_bf16 v151, v80, v128, 0
  v_dot2_f32_bf16 v149, v81, v121, v149
  v_dot2_f32_bf16 v151, v81, v129, v151
  v_dot2_f32_bf16 v149, v82, v122, v149
  v_dot2_f32_bf16 v151, v82, v130, v151
  v_dot2_f32_bf16 v149, v83, v123, v149
  v_dot2_f32_bf16 v151, v83, v131, v151
  s_waitcnt vmcnt(4)
  s_cbranch_vccnz L_bz40
  s_waitcnt vmcnt(2)
  s_cbranch_scc1 L_bz40
  s_waitcnt vmcnt(1)
L_bz40:
  buffer_load_dwordx4 v[112:115], v1, s[48:51], s17 offen nt
  v_permlane16_swap_b32 v138, v148
  v_permlane16_swap_b32 v139, v149
  v_permlane16_swap_b32 v146, v150
  v_permlane16_swap_b32 v147, v151
  v_pk_add_f32 v[138:139], v[138:139], v[148:149]
  v_pk_add_f32 v[146:147], v[146:147], v[150:151]
  s_nop 0
  v_add_f32_dpp v138, v138, v138 quad_perm:[1,0,3,2] row_mask:0xf bank_mask:0xf
  v_add_f32_dpp v139, v139, v139 quad_perm:[1,0,3,2] row_mask:0xf bank_mask:0xf
  v_add_f32_dpp v146, v146, v146 quad_perm:[1,0,3,2] row_mask:0xf bank_mask:0xf
  v_add_f32_dpp v147, v147, v147 quad_perm:[1,0,3,2] row_mask:0xf bank_mask:0xf
  v_add_f32_dpp v138, v138, v138 quad_perm:[2,3,0,1] row_mask:0xf bank_mask:0xf
  v_add_f32_dpp v139, v139, v139 quad_perm:[2,3,0,1] row_mask:0xf bank_mask:0xf
  v_add_f32_dpp v146, v146, v146 quad_perm:[2,3,0,1] row_mask:0xf bank_mask:0xf
  v_add_f32_dpp v147, v147, v147 quad_perm:[2,3,0,1] row_mask:0xf bank_mask:0xf
  v_add_f32_dpp v138, v138, v138 row_half_mirror row_mask:0xf bank_mask:0xf
  v_add_f32_dpp v139, v139, v139 row_half_mirror row_mask:0xf bank_mask:0xf
  v_add_f32_dpp v146, v146, v146 row_half_mirror row_mask:0xf bank_mask:0xf
  v_add_f32_dpp v147, v147, v147 row_half_mirror row_mask:0xf bank_mask:0xf
  v_add_f32_dpp v138, v138, v138 row_mirror row_mask:0xf bank_mask:0xf
  v_add_f32_dpp v139, v139, v139 row_mirror row_mask:0xf bank_mask:0xf
  v_add_f32_dpp v146, v146, v146 row_mirror row_mask:0xf bank_mask:0xf
  v_add_f32_dpp v147, v147, v147 row_mirror row_mask:0xf bank_mask:0xf
  v_max3_f32 v160, v138, v139, v160
  v_max3_f32 v161, v146, v147, v161
  v_mov_b32 v148, v160
  v_mov_b32 v149, v161
  s_nop 0
  v_permlane16_swap_b32 v160, v148
  v_permlane16_swap_b32 v161, v149
  v_max_f32 v160, v160, v148
  v_max_f32 v161, v161, v149
  v_mov_b32 v148, v160
  v_mov_b32 v149, v161
  s_nop 0
  v_permlane32_swap_b32 v160, v148
  v_permlane32_swap_b32 v161, v149
  v_max_f32 v160, v160, v148
  v_max_f32 v161, v161, v149
  v_mul_f32 v152, s67, v160
  v_mul_f32 v154, s67, v161
  v_fma_f32 v132, v132, s67, -v152
  v_fma_f32 v133, v133, s67, -v152
  v_fma_f32 v134, v134, s67, -v152
  v_fma_f32 v135, v135, s67, -v152
  v_fma_f32 v136, v136, s67, -v152
  v_fma_f32 v137, v137, s67, -v152
  v_fma_f32 v138, v138, s67, -v152
  v_fma_f32 v139, v139, s67, -v152
  v_fma_f32 v140, v140, s67, -v154
  v_fma_f32 v141, v141, s67, -v154
  v_fma_f32 v142, v142, s67, -v154
  v_fma_f32 v143, v143, s67, -v154
  v_fma_f32 v144, v144, s67, -v154
  v_fma_f32 v145, v145, s67, -v154
  v_fma_f32 v146, v146, s67, -v154
  v_fma_f32 v147, v147, s67, -v154
  v_exp_f32 v132, v132
  v_exp_f32 v133, v133
  v_exp_f32 v134, v134
  v_exp_f32 v135, v135
  v_exp_f32 v136, v136
  v_exp_f32 v137, v137
  v_exp_f32 v138, v138
  v_exp_f32 v139, v139
  v_exp_f32 v140, v140
  v_exp_f32 v141, v141
  v_exp_f32 v142, v142
  v_exp_f32 v143, v143
  v_exp_f32 v144, v144
  v_exp_f32 v145, v145
  v_exp_f32 v146, v146
  v_exp_f32 v147, v147
  v_pk_add_f32 v[148:149], v[132:133], v[134:135]
  v_pk_add_f32 v[150:151], v[140:141], v[142:143]
  v_pk_add_f32 v[156:157], v[136:137], v[138:139]
  v_pk_add_f32 v[158:159], v[144:145], v[146:147]
  v_pk_add_f32 v[148:149], v[148:149], v[156:157]
  v_pk_add_f32 v[150:151], v[150:151], v[158:159]
  v_mov_b64 v[156:157], v[132:133]
  v_mov_b64 v[158:159], v[140:141]
  s_nop 0
  v_permlane16_swap_b32 v132, v156
  v_permlane16_swap_b32 v133, v157
  v_permlane16_swap_b32 v140, v158
  v_permlane16_swap_b32 v141, v159
  v_permlane16_swap_b32 v148, v149
  v_permlane16_swap_b32 v150, v151
  v_add_f32 v148, v148, v149
  v_add_f32 v150, v150, v151
  v_mov_b32 v149, v148
  v_mov_b32 v151, v150
  s_nop 0
  v_permlane16_swap_b32 v148, v149
  v_permlane16_swap_b32 v150, v151
  v_add_f32 v148, v148, v149
  v_add_f32 v150, v150, v151
  v_mov_b32 v149, v148
  v_mov_b32 v151, v150
  s_nop 0
  v_permlane32_swap_b32 v148, v149
  v_permlane32_swap_b32 v150, v151
  v_add_f32 v153, v148, v149
  v_add_f32 v155, v150, v151
  s_mov_b64 exec, 1
  ds_write_b64 v164, v[152:153] offset:4480
  ds_write_b64 v164, v[154:155] offset:4544
  s_mov_b64 exec, -1
  v_lshlrev_b32 v148, 16, v84
  v_and_b32 v149, s66, v84
  v_lshlrev_b32 v150, 16, v85
  v_and_b32 v151, s66, v85
  v_lshlrev_b32 v152, 16, v86
  v_and_b32 v153, s66, v86
  v_lshlrev_b32 v154, 16, v87
  v_and_b32 v155, s66, v87
  s_waitcnt vmcnt(4)
  s_cbranch_vccnz L_bz41
  s_waitcnt vmcnt(2)
  s_cbranch_scc1 L_bz41
  s_waitcnt vmcnt(1)
L_bz41:
  buffer_load_dwordx4 v[4:7], v1, s[48:51], s18 offen nt
  s_memrealtime s[82:83]
  v_pk_mul_f32 v[116:117], v[148:149], v[132:133] op_sel_hi:[1,0]
  v_pk_mul_f32 v[118:119], v[150:151], v[132:133] op_sel_hi:[1,0]
  v_pk_mul_f32 v[120:121], v[152:153], v[132:133] op_sel_hi:[1,0]
  v_pk_mul_f32 v[122:123], v[154:155], v[132:133] op_sel_hi:[1,0]
  v_pk_mul_f32 v[124:125], v[148:149], v[140:141] op_sel_hi:[1,0]
  v_pk_mul_f32 v[126:127], v[150:151], v[140:141] op_sel_hi:[1,0]
  v_pk_mul_f32 v[128:129], v[152:153], v[140:141] op_sel_hi:[1,0]
  v_pk_mul_f32 v[130:131], v[154:155], v[140:141] op_sel_hi:[1,0]
  v_lshlrev_b32 v148, 16, v88
  v_and_b32 v149, s66, v88
  v_lshlrev_b32 v150, 16, v89
  v_and_b32 v151, s66, v89
  v_lshlrev_b32 v152, 16, v90
  v_and_b32 v153, s66, v90
  v_lshlrev_b32 v154, 16, v91
  v_and_b32 v155, s66, v91
  s_waitcnt vmcnt(4)
  s_cbranch_vccnz L_bz42
  s_waitcnt vmcnt(2)
  s_cbranch_scc1 L_bz42
  s_waitcnt vmcnt(1)
L_bz42:
  buffer_load_dwordx4 v[8:11], v1, s[48:51], s19 offen nt
  s_waitcnt lgkmcnt(0)
  s_sub_u32 s80, s82, s54
  s_sub_u32 s80, s80, 1755
  s_cmp_gt_i32 s80, 80
  s_cselect_b64 vcc, 1, 0
  s_cmp_gt_i32 s80, 0
  v_pk_fma_f32 v[116:117], v[148:149], v[156:157], v[116:117] op_sel_hi:[1,0,1]
  v_pk_fma_f32 v[118:119], v[150:151], v[156:157], v[118:119] op_sel_hi:[1,0,1]
  v_pk_fma_f32 v[120:121], v[152:153], v[156:157], v[120:121] op_sel_hi:[1,0,1]
  v_pk_fma_f32 v[122:123], v[154:155], v[156:157], v[122:123] op_sel_hi:[1,0,1]
  v_pk_fma_f32 v[124:125], v[148:149], v[158:159], v[124:125] op_sel_hi:[1,0,1]
  v_pk_fma_f32 v[126:127], v[150:151], v[158:159], v[126:127] op_sel_hi:[1,0,1]
  v_pk_fma_f32 v[128:129], v[152:153], v[158:159], v[128:129] op_sel_hi:[1,0,1]
  v_pk_fma_f32 v[130:131], v[154:155], v[158:159], v[130:131] op_sel_hi:[1,0,1]
  v_lshlrev_b32 v148, 16, v92
  v_and_b32 v149, s66, v92
  v_lshlrev_b32 v150, 16, v93
  v_and_b32 v151, s66, v93
  v_lshlrev_b32 v152, 16, v94
  v_and_b32 v153, s66, v94
  v_lshlrev_b32 v154, 16, v95
  v_and_b32 v155, s66, v95
  s_waitcnt vmcnt(4)
  s_cbranch_vccnz L_bz43
  s_waitcnt vmcnt(2)
  s_cbranch_scc1 L_bz43
  s_waitcnt vmcnt(1)
L_bz43:
  buffer_load_dwordx4 v[12:15], v1, s[48:51], s20 offen nt
  v_pk_fma_f32 v[116:117], v[148:149], v[132:133], v[116:117] op_sel:[0,1,0]
  v_pk_fma_f32 v[118:119], v[150:151], v[132:133], v[118:119] op_sel:[0,1,0]
  v_pk_fma_f32 v[120:121], v[152:153], v[132:133], v[120:121] op_sel:[0,1,0]
  v_pk_fma_f32 v[122:123], v[154:155], v[132:133], v[122:123] op_sel:[0,1,0]
  v_pk_fma_f32 v[124:125], v[148:149], v[140:141], v[124:125] op_sel:[0,1,0]
  v_pk_fma_f32 v[126:127], v[150:151], v[140:141], v[126:127] op_sel:[0,1,0]
  v_pk_fma_f32 v[128:129], v[152:153], v[140:141], v[128:129] op_sel:[0,1,0]
  v_pk_fma_f32 v[130:131], v[154:155], v[140:141], v[130:131] op_sel:[0,1,0]
  v_lshlrev_b32 v148, 16, v96
  v_and_b32 v149, s66, v96
  v_lshlrev_b32 v150, 16, v97
  v_and_b32 v151, s66, v97
  v_lshlrev_b32 v152, 16, v98
  v_and_b32 v153, s66, v98
  v_lshlrev_b32 v154, 16, v99
  v_and_b32 v155, s66, v99
  s_waitcnt vmcnt(4)
  s_cbranch_vccnz L_bz44
  s_waitcnt vmcnt(2)
  s_cbranch_scc1 L_bz44
  s_waitcnt vmcnt(1)
L_bz44:
  buffer_load_dwordx4 v[16:19], v1, s[48:51], s21 offen nt
  v_pk_fma_f32 v[116:117], v[148:149], v[156:157], v[116:117] op_sel:[0,1,0]
  v_pk_fma_f32 v[118:119], v[150:151], v[156:157], v[118:119] op_sel:[0,1,0]
  v_pk_fma_f32 v[120:121], v[152:153], v[156:157], v[120:121] op_sel:[0,1,0]
  v_pk_fma_f32 v[122:123], v[154:155], v[156:157], v[122:123] op_sel:[0,1,0]
  v_pk_fma_f32 v[124:125], v[148:149], v[158:159], v[124:125] op_sel:[0,1,0]
  v_pk_fma_f32 v[126:127], v[150:151], v[158:159], v[126:127] op_sel:[0,1,0]
  v_pk_fma_f32 v[128:129], v[152:153], v[158:159], v[128:129] op_sel:[0,1,0]
  v_pk_fma_f32 v[130:131], v[154:155], v[158:159], v[130:131] op_sel:[0,1,0]
  v_mov_b64 v[156:157], v[134:135]
  v_mov_b64 v[158:159], v[142:143]
  s_nop 0
  v_permlane16_swap_b32 v134, v156
  v_permlane16_swap_b32 v135, v157
  v_permlane16_swap_b32 v142, v158
  v_permlane16_swap_b32 v143, v159
  v_lshlrev_b32 v148, 16, v100
  v_and_b32 v149, s66, v100
  v_lshlrev_b32 v150, 16, v101
  v_and_b32 v151, s66, v101
  v_lshlrev_b32 v152, 16, v102
  v_and_b32 v153, s66, v102
  v_lshlrev_b32 v154, 16, v103
  v_and_b32 v155, s66, v103
  s_waitcnt vmcnt(4)
  s_cbranch_vccnz L_bz45
  s_waitcnt vmcnt(2)
  s_cbranch_scc1 L_bz45
  s_waitcnt vmcnt(1)
L_bz45:
  buffer_load_dwordx4 v[20:23], v1, s[48:51], s22 offen nt
  s_memrealtime s[82:83]
  v_pk_fma_f32 v[116:117], v[148:149], v[134:135], v[116:117] op_sel_hi:[1,0,1]
  v_pk_fma_f32 v[118:119], v[150:151], v[134:135], v[118:119] op_sel_hi:[1,0,1]
  v_pk_fma_f32 v[120:121], v[152:153], v[134:135], v[120:121] op_sel_hi:[1,0,1]
  v_pk_fma_f32 v[122:123], v[154:155], v[134:135], v[122:123] op_sel_hi:[1,0,1]
  v_pk_fma_f32 v[124:125], v[148:149], v[142:143], v[124:125] op_sel_hi:[1,0,1]
  v_pk_fma_f32 v[126:127], v[150:151], v[142:143], v[126:127] op_sel_hi:[1,0,1]
  v_pk_fma_f32 v[128:129], v[152:153], v[142:143], v[128:129] op_sel_hi:[1,0,1]
  v_pk_fma_f32 v[130:131], v[154:155], v[142:143], v[130:131] op_sel_hi:[1,0,1]
  v_lshlrev_b32 v148, 16, v104
  v_and_b32 v149, s66, v104
  v_lshlrev_b32 v150, 16, v105
  v_and_b32 v151, s66, v105
  v_lshlrev_b32 v152, 16, v106
  v_and_b32 v153, s66, v106
  v_lshlrev_b32 v154, 16, v107
  v_and_b32 v155, s66, v107
  s_waitcnt vmcnt(4)
  s_cbranch_vccnz L_bz46
  s_waitcnt vmcnt(2)
  s_cbranch_scc1 L_bz46
  s_waitcnt vmcnt(1)
L_bz46:
  buffer_load_dwordx4 v[24:27], v1, s[48:51], s23 offen nt
  s_waitcnt lgkmcnt(0)
  s_sub_u32 s80, s82, s54
  s_sub_u32 s80, s80, 1862
  s_cmp_gt_i32 s80, 80
  s_cselect_b64 vcc, 1, 0
  s_cmp_gt_i32 s80, 0
  v_pk_fma_f32 v[116:117], v[148:149], v[156:157], v[116:117] op_sel_hi:[1,0,1]
  v_pk_fma_f32 v[118:119], v[150:151], v[156:157], v[118:119] op_sel_hi:[1,0,1]
  v_pk_fma_f32 v[120:121], v[152:153], v[156:157], v[120:121] op_sel_hi:[1,0,1]
  v_pk_fma_f32 v[122:123], v[154:155], v[156:157], v[122:123] op_sel_hi:[1,0,1]
  v_pk_fma_f32 v[124:125], v[148:149], v[158:159], v[124:125] op_sel_hi:[1,0,1]
  v_pk_fma_f32 v[126:127], v[150:151], v[158:159], v[126:127] op_sel_hi:[1,0,1]
  v_pk_fma_f32 v[128:129], v[152:153], v[158:159], v[128:129] op_sel_hi:[1,0,1]
  v_pk_fma_f32 v[130:131], v[154:155], v[158:159], v[130:131] op_sel_hi:[1,0,1]
  v_lshlrev_b32 v148, 16, v108
  v_and_b32 v149, s66, v108
  v_lshlrev_b32 v150, 16, v109
  v_and_b32 v151, s66, v109
  v_lshlrev_b32 v152, 16, v110
  v_and_b32 v153, s66, v110
  v_lshlrev_b32 v154, 16, v111
  v_and_b32 v155, s66, v111
  s_waitcnt vmcnt(4)
  s_cbranch_vccnz L_bz47
  s_waitcnt vmcnt(2)
  s_cbranch_scc1 L_bz47
  s_waitcnt vmcnt(1)
L_bz47:
  buffer_load_dwordx4 v[28:31], v1, s[48:51], s24 offen nt
  v_pk_fma_f32 v[116:117], v[148:149], v[134:135], v[116:117] op_sel:[0,1,0]
  v_pk_fma_f32 v[118:119], v[150:151], v[134:135], v[118:119] op_sel:[0,1,0]
  v_pk_fma_f32 v[120:121], v[152:153], v[134:135], v[120:121] op_sel:[0,1,0]
  v_pk_fma_f32 v[122:123], v[154:155], v[134:135], v[122:123] op_sel:[0,1,0]
  v_pk_fma_f32 v[124:125], v[148:149], v[142:143], v[124:125] op_sel:[0,1,0]
  v_pk_fma_f32 v[126:127], v[150:151], v[142:143], v[126:127] op_sel:[0,1,0]
  v_pk_fma_f32 v[128:129], v[152:153], v[142:143], v[128:129] op_sel:[0,1,0]
  v_pk_fma_f32 v[130:131], v[154:155], v[142:143], v[130:131] op_sel:[0,1,0]
  v_lshlrev_b32 v148, 16, v112
  v_and_b32 v149, s66, v112
  v_lshlrev_b32 v150, 16, v113
  v_and_b32 v151, s66, v113
  v_lshlrev_b32 v152, 16, v114
  v_and_b32 v153, s66, v114
  v_lshlrev_b32 v154, 16, v115
  v_and_b32 v155, s66, v115
  s_waitcnt vmcnt(4)
  s_cbranch_vccnz L_bz48
  s_waitcnt vmcnt(2)
  s_cbranch_scc1 L_bz48
  s_waitcnt vmcnt(1)
L_bz48:
  buffer_load_dwordx4 v[32:35], v1, s[48:51], s25 offen nt
  v_pk_fma_f32 v[116:117], v[148:149], v[156:157], v[116:117] op_sel:[0,1,0]
  v_pk_fma_f32 v[118:119], v[150:151], v[156:157], v[118:119] op_sel:[0,1,0]
  v_pk_fma_f32 v[120:121], v[152:153], v[156:157], v[120:121] op_sel:[0,1,0]
  v_pk_fma_f32 v[122:123], v[154:155], v[156:157], v[122:123] op_sel:[0,1,0]
  v_pk_fma_f32 v[124:125], v[148:149], v[158:159], v[124:125] op_sel:[0,1,0]
  v_pk_fma_f32 v[126:127], v[150:151], v[158:159], v[126:127] op_sel:[0,1,0]
  v_pk_fma_f32 v[128:129], v[152:153], v[158:159], v[128:129] op_sel:[0,1,0]
  v_pk_fma_f32 v[130:131], v[154:155], v[158:159], v[130:131] op_sel:[0,1,0]
  v_mov_b64 v[156:157], v[136:137]
  v_mov_b64 v[158:159], v[144:145]
  s_nop 0
  v_permlane16_swap_b32 v136, v156
  v_permlane16_swap_b32 v137, v157
  v_permlane16_swap_b32 v144, v158
  v_permlane16_swap_b32 v145, v159
  v_lshlrev_b32 v148, 16, v4
  v_and_b32 v149, s66, v4
  v_lshlrev_b32 v150, 16, v5
  v_and_b32 v151, s66, v5
  v_lshlrev_b32 v152, 16, v6
  v_and_b32 v153, s66, v6
  v_lshlrev_b32 v154, 16, v7
  v_and_b32 v155, s66, v7
  s_waitcnt vmcnt(4)
  s_cbranch_vccnz L_bz49
  s_waitcnt vmcnt(2)
  s_cbranch_scc1 L_bz49
  s_waitcnt vmcnt(1)
L_bz49:
  buffer_load_dwordx4 v[36:39], v1, s[72:75], s60 offen nt
  s_memrealtime s[82:83]
  v_pk_fma_f32 v[116:117], v[148:149], v[136:137], v[116:117] op_sel_hi:[1,0,1]
  v_pk_fma_f32 v[118:119], v[150:151], v[136:137], v[118:119] op_sel_hi:[1,0,1]
  v_pk_fma_f32 v[120:121], v[152:153], v[136:137], v[120:121] op_sel_hi:[1,0,1]
  v_pk_fma_f32 v[122:123], v[154:155], v[136:137], v[122:123] op_sel_hi:[1,0,1]
  v_pk_fma_f32 v[124:125], v[148:149], v[144:145], v[124:125] op_sel_hi:[1,0,1]
  v_pk_fma_f32 v[126:127], v[150:151], v[144:145], v[126:127] op_sel_hi:[1,0,1]
  v_pk_fma_f32 v[128:129], v[152:153], v[144:145], v[128:129] op_sel_hi:[1,0,1]
  v_pk_fma_f32 v[130:131], v[154:155], v[144:145], v[130:131] op_sel_hi:[1,0,1]
  v_lshlrev_b32 v148, 16, v8
  v_and_b32 v149, s66, v8
  v_lshlrev_b32 v150, 16, v9
  v_and_b32 v151, s66, v9
  v_lshlrev_b32 v152, 16, v10
  v_and_b32 v153, s66, v10
  v_lshlrev_b32 v154, 16, v11
  v_and_b32 v155, s66, v11
  s_waitcnt vmcnt(4)
  s_cbranch_vccnz L_bz50
  s_waitcnt vmcnt(2)
  s_cbranch_scc1 L_bz50
  s_waitcnt vmcnt(1)
L_bz50:
  buffer_load_dwordx4 v[40:43], v1, s[72:75], s61 offen nt
  s_waitcnt lgkmcnt(0)
  s_sub_u32 s80, s82, s54
  s_sub_u32 s80, s80, 1968
  s_cmp_gt_i32 s80, 80
  s_cselect_b64 vcc, 1, 0
  s_cmp_gt_i32 s80, 0
  v_pk_fma_f32 v[116:117], v[148:149], v[156:157], v[116:117] op_sel_hi:[1,0,1]
  v_pk_fma_f32 v[118:119], v[150:151], v[156:157], v[118:119] op_sel_hi:[1,0,1]
  v_pk_fma_f32 v[120:121], v[152:153], v[156:157], v[120:121] op_sel_hi:[1,0,1]
  v_pk_fma_f32 v[122:123], v[154:155], v[156:157], v[122:123] op_sel_hi:[1,0,1]
  v_pk_fma_f32 v[124:125], v[148:149], v[158:159], v[124:125] op_sel_hi:[1,0,1]
  v_pk_fma_f32 v[126:127], v[150:151], v[158:159], v[126:127] op_sel_hi:[1,0,1]
  v_pk_fma_f32 v[128:129], v[152:153], v[158:159], v[128:129] op_sel_hi:[1,0,1]
  v_pk_fma_f32 v[130:131], v[154:155], v[158:159], v[130:131] op_sel_hi:[1,0,1]
  v_lshlrev_b32 v148, 16, v12
  v_and_b32 v149, s66, v12
  v_lshlrev_b32 v150, 16, v13
  v_and_b32 v151, s66, v13
  v_lshlrev_b32 v152, 16, v14
  v_and_b32 v153, s66, v14
  v_lshlrev_b32 v154, 16, v15
  v_and_b32 v155, s66, v15
  s_waitcnt vmcnt(4)
  s_cbranch_vccnz L_bz51
  s_waitcnt vmcnt(2)
  s_cbranch_scc1 L_bz51
  s_waitcnt vmcnt(1)
L_bz51:
  buffer_load_dwordx4 v[44:47], v1, s[72:75], s68 offen nt
  v_pk_fma_f32 v[116:117], v[148:149], v[136:137], v[116:117] op_sel:[0,1,0]
  v_pk_fma_f32 v[118:119], v[150:151], v[136:137], v[118:119] op_sel:[0,1,0]
  v_pk_fma_f32 v[120:121], v[152:153], v[136:137], v[120:121] op_sel:[0,1,0]
  v_pk_fma_f32 v[122:123], v[154:155], v[136:137], v[122:123] op_sel:[0,1,0]
  v_pk_fma_f32 v[124:125], v[148:149], v[144:145], v[124:125] op_sel:[0,1,0]
  v_pk_fma_f32 v[126:127], v[150:151], v[144:145], v[126:127] op_sel:[0,1,0]
  v_pk_fma_f32 v[128:129], v[152:153], v[144:145], v[128:129] op_sel:[0,1,0]
  v_pk_fma_f32 v[130:131], v[154:155], v[144:145], v[130:131] op_sel:[0,1,0]
  v_lshlrev_b32 v148, 16, v16
  v_and_b32 v149, s66, v16
  v_lshlrev_b32 v150, 16, v17
  v_and_b32 v151, s66, v17
  v_lshlrev_b32 v152, 16, v18
  v_and_b32 v153, s66, v18
  v_lshlrev_b32 v154, 16, v19
  v_and_b32 v155, s66, v19
  s_waitcnt vmcnt(4)
  s_cbranch_vccnz L_bz52
  s_waitcnt vmcnt(2)
  s_cbranch_scc1 L_bz52
  s_waitcnt vmcnt(1)
L_bz52:
  buffer_load_dwordx4 v[48:51], v1, s[72:75], s69 offen nt
  v_pk_fma_f32 v[116:117], v[148:149], v[156:157], v[116:117] op_sel:[0,1,0]
  v_pk_fma_f32 v[118:119], v[150:151], v[156:157], v[118:119] op_sel:[0,1,0]
  v_pk_fma_f32 v[120:121], v[152:153], v[156:157], v[120:121] op_sel:[0,1,0]
  v_pk_fma_f32 v[122:123], v[154:155], v[156:157], v[122:123] op_sel:[0,1,0]
  v_pk_fma_f32 v[124:125], v[148:149], v[158:159], v[124:125] op_sel:[0,1,0]
  v_pk_fma_f32 v[126:127], v[150:151], v[158:159], v[126:127] op_sel:[0,1,0]
  v_pk_fma_f32 v[128:129], v[152:153], v[158:159], v[128:129] op_sel:[0,1,0]
  v_pk_fma_f32 v[130:131], v[154:155], v[158:159], v[130:131] op_sel:[0,1,0]
  v_mov_b64 v[156:157], v[138:139]
  v_mov_b64 v[158:159], v[146:147]
  s_nop 0
  v_permlane16_swap_b32 v138, v156
  v_permlane16_swap_b32 v139, v157
  v_permlane16_swap_b32 v146, v158
  v_permlane16_swap_b32 v147, v159
  v_lshlrev_b32 v148, 16, v20
  v_and_b32 v149, s66, v20
  v_lshlrev_b32 v150, 16, v21
  v_and_b32 v151, s66, v21
  v_lshlrev_b32 v152, 16, v22
  v_and_b32 v153, s66, v22
  v_lshlrev_b32 v154, 16, v23
  v_and_b32 v155, s66, v23
  s_waitcnt vmcnt(4)
  s_cbranch_vccnz L_bz53
  s_waitcnt vmcnt(2)
  s_cbranch_scc1 L_bz53
  s_waitcnt vmcnt(1)
L_bz53:
  buffer_load_dwordx4 v[52:55], v1, s[72:75], s14 offen nt
  s_memrealtime s[82:83]
  v_pk_fma_f32 v[116:117], v[148:149], v[138:139], v[116:117] op_sel_hi:[1,0,1]
  v_pk_fma_f32 v[118:119], v[150:151], v[138:139], v[118:119] op_sel_hi:[1,0,1]
  v_pk_fma_f32 v[120:121], v[152:153], v[138:139], v[120:121] op_sel_hi:[1,0,1]
  v_pk_fma_f32 v[122:123], v[154:155], v[138:139], v[122:123] op_sel_hi:[1,0,1]
  v_pk_fma_f32 v[124:125], v[148:149], v[146:147], v[124:125] op_sel_hi:[1,0,1]
  v_pk_fma_f32 v[126:127], v[150:151], v[146:147], v[126:127] op_sel_hi:[1,0,1]
  v_pk_fma_f32 v[128:129], v[152:153], v[146:147], v[128:129] op_sel_hi:[1,0,1]
  v_pk_fma_f32 v[130:131], v[154:155], v[146:147], v[130:131] op_sel_hi:[1,0,1]
  v_lshlrev_b32 v148, 16, v24
  v_and_b32 v149, s66, v24
  v_lshlrev_b32 v150, 16, v25
  v_and_b32 v151, s66, v25
  v_lshlrev_b32 v152, 16, v26
  v_and_b32 v153, s66, v26
  v_lshlrev_b32 v154, 16, v27
  v_and_b32 v155, s66, v27
  s_waitcnt vmcnt(4)
  s_cbranch_vccnz L_bz54
  s_waitcnt vmcnt(2)
  s_cbranch_scc1 L_bz54
  s_waitcnt vmcnt(1)
L_bz54:
  buffer_load_dwordx4 v[56:59], v1, s[72:75], s15 offen nt
  s_waitcnt lgkmcnt(0)
  s_sub_u32 s80, s82, s54
  s_sub_u32 s80, s80, 2075
  s_cmp_gt_i32 s80, 80
  s_cselect_b64 vcc, 1, 0
  s_cmp_gt_i32 s80, 0
  v_pk_fma_f32 v[116:117], v[148:149], v[156:157], v[116:117] op_sel_hi:[1,0,1]
  v_pk_fma_f32 v[118:119], v[150:151], v[156:157], v[118:119] op_sel_hi:[1,0,1]
  v_pk_fma_f32 v[120:121], v[152:153], v[156:157], v[120:121] op_sel_hi:[1,0,1]
  v_pk_fma_f32 v[122:123], v[154:155], v[156:157], v[122:123] op_sel_hi:[1,0,1]
  v_pk_fma_f32 v[124:125], v[148:149], v[158:159], v[124:125] op_sel_hi:[1,0,1]
  v_pk_fma_f32 v[126:127], v[150:151], v[158:159], v[126:127] op_sel_hi:[1,0,1]
  v_pk_fma_f32 v[128:129], v[152:153], v[158:159], v[128:129] op_sel_hi:[1,0,1]
  v_pk_fma_f32 v[130:131], v[154:155], v[158:159], v[130:131] op_sel_hi:[1,0,1]
  v_lshlrev_b32 v148, 16, v28
  v_and_b32 v149, s66, v28
  v_lshlrev_b32 v150, 16, v29
  v_and_b32 v151, s66, v29
  v_lshlrev_b32 v152, 16, v30
  v_and_b32 v153, s66, v30
  v_lshlrev_b32 v154, 16, v31
  v_and_b32 v155, s66, v31
  s_waitcnt vmcnt(4)
  s_cbranch_vccnz L_bz55
  s_waitcnt vmcnt(2)
  s_cbranch_scc1 L_bz55
  s_waitcnt vmcnt(1)
L_bz55:
  buffer_load_dwordx4 v[60:63], v1, s[72:75], s16 offen nt
  v_pk_fma_f32 v[116:117], v[148:149], v[138:139], v[116:117] op_sel:[0,1,0]
  v_pk_fma_f32 v[118:119], v[150:151], v[138:139], v[118:119] op_sel:[0,1,0]
  v_pk_fma_f32 v[120:121], v[152:153], v[138:139], v[120:121] op_sel:[0,1,0]
  v_pk_fma_f32 v[122:123], v[154:155], v[138:139], v[122:123] op_sel:[0,1,0]
  v_pk_fma_f32 v[124:125], v[148:149], v[146:147], v[124:125] op_sel:[0,1,0]
  v_pk_fma_f32 v[126:127], v[150:151], v[146:147], v[126:127] op_sel:[0,1,0]
  v_pk_fma_f32 v[128:129], v[152:153], v[146:147], v[128:129] op_sel:[0,1,0]
  v_pk_fma_f32 v[130:131], v[154:155], v[146:147], v[130:131] op_sel:[0,1,0]
  v_lshlrev_b32 v148, 16, v32
  v_and_b32 v149, s66, v32
  v_lshlrev_b32 v150, 16, v33
  v_and_b32 v151, s66, v33
  v_lshlrev_b32 v152, 16, v34
  v_and_b32 v153, s66, v34
  v_lshlrev_b32 v154, 16, v35
  v_and_b32 v155, s66, v35
  s_waitcnt vmcnt(4)
  s_cbranch_vccnz L_bz56
  s_waitcnt vmcnt(2)
  s_cbranch_scc1 L_bz56
  s_waitcnt vmcnt(1)
L_bz56:
  buffer_load_dwordx4 v[64:67], v1, s[72:75], s17 offen nt
  v_pk_fma_f32 v[116:117], v[148:149], v[156:157], v[116:117] op_sel:[0,1,0]
  v_pk_fma_f32 v[118:119], v[150:151], v[156:157], v[118:119] op_sel:[0,1,0]
  v_pk_fma_f32 v[120:121], v[152:153], v[156:157], v[120:121] op_sel:[0,1,0]
  v_pk_fma_f32 v[122:123], v[154:155], v[156:157], v[122:123] op_sel:[0,1,0]
  v_pk_fma_f32 v[124:125], v[148:149], v[158:159], v[124:125] op_sel:[0,1,0]
  v_pk_fma_f32 v[126:127], v[150:151], v[158:159], v[126:127] op_sel:[0,1,0]
  v_pk_fma_f32 v[128:129], v[152:153], v[158:159], v[128:129] op_sel:[0,1,0]
  v_pk_fma_f32 v[130:131], v[154:155], v[158:159], v[130:131] op_sel:[0,1,0]
  v_permlane32_swap_b32 v116, v120
  v_permlane32_swap_b32 v117, v121
  v_permlane32_swap_b32 v118, v122
  v_permlane32_swap_b32 v119, v123
  v_permlane32_swap_b32 v124, v128
  v_permlane32_swap_b32 v125, v129
  v_permlane32_swap_b32 v126, v130
  v_permlane32_swap_b32 v127, v131
  v_pk_add_f32 v[116:117], v[116:117], v[120:121]
  v_pk_add_f32 v[118:119], v[118:119], v[122:123]
  v_pk_add_f32 v[124:125], v[124:125], v[128:129]
  v_pk_add_f32 v[126:127], v[126:127], v[130:131]
  ds_write_b128 v163, v[116:119] offset:21504
  ds_write_b128 v163, v[124:127] offset:29696
  s_mov_b64 exec, 1
  ds_add_u32 v162, v3 offset:4116
  s_mov_b64 exec, -1
  s_mov_b32 s65, 524288
L_lw57:
  ds_read_b32 v148, v162 offset:4100
  s_waitcnt lgkmcnt(0)
  v_cmp_ne_u32 vcc, 1, v148
  s_cbranch_vccz L_lwok57
  s_sleep 1
  s_sub_u32 s65, s65, 1
  s_cmp_lg_u32 s65, 0
  s_cbranch_scc1 L_lw57
L_lwok57:
  ds_read_b128 v[120:123], v2 offset:512
  ds_read_b32 v148, v162 offset:4128
  s_waitcnt lgkmcnt(0)
  v_readfirstlane_b32 s71, v148
  s_cmp_gt_i32 s80, 80
  s_cselect_b64 vcc, 1, 0
  s_cmp_gt_i32 s80, 0
  v_dot2_f32_bf16 v132, v36, v120, 0
  v_dot2_f32_bf16 v132, v37, v121, v132
  v_dot2_f32_bf16 v132, v38, v122, v132
  v_dot2_f32_bf16 v132, v39, v123, v132
  s_waitcnt vmcnt(4)
  s_cbranch_vccnz L_bz58
  s_waitcnt vmcnt(2)
  s_cbranch_scc1 L_bz58
  s_waitcnt vmcnt(1)
L_bz58:
  buffer_load_dwordx4 v[68:71], v1, s[72:75], s18 offen nt
  s_memrealtime s[82:83]
  v_dot2_f32_bf16 v148, v40, v120, 0
  v_dot2_f32_bf16 v148, v41, v121, v148
  v_dot2_f32_bf16 v148, v42, v122, v148
  v_dot2_f32_bf16 v148, v43, v123, v148
  s_waitcnt vmcnt(4)
  s_cbranch_vccnz L_bz59
  s_waitcnt vmcnt(2)
  s_cbranch_scc1 L_bz59
  s_waitcnt vmcnt(1)
L_bz59:
  buffer_load_dwordx4 v[72:75], v1, s[72:75], s19 offen nt
  s_waitcnt lgkmcnt(0)
  s_sub_u32 s80, s82, s54
  s_sub_u32 s80, s80, 2182
  s_cmp_gt_i32 s80, 80
  s_cselect_b64 vcc, 1, 0
  s_cmp_gt_i32 s80, 0
  v_dot2_f32_bf16 v133, v44, v120, 0
  v_dot2_f32_bf16 v133, v45, v121, v133
  v_dot2_f32_bf16 v133, v46, v122, v133
  v_dot2_f32_bf16 v133, v47, v123, v133
  s_waitcnt vmcnt(4)
  s_cbranch_vccnz L_bz60
  s_waitcnt vmcnt(2)
  s_cbranch_scc1 L_bz60
  s_waitcnt vmcnt(1)
L_bz60:
  buffer_load_dwordx4 v[76:79], v1, s[72:75], s20 offen nt
  v_dot2_f32_bf16 v149, v48, v120, 0
  v_dot2_f32_bf16 v149, v49, v121, v149
  v_dot2_f32_bf16 v149, v50, v122, v149
  v_dot2_f32_bf16 v149, v51, v123, v149
  s_waitcnt vmcnt(4)
  s_cbranch_vccnz L_bz61
  s_waitcnt vmcnt(2)
  s_cbranch_scc1 L_bz61
  s_waitcnt vmcnt(1)
L_bz61:
  buffer_load_dwordx4 v[80:83], v1, s[72:75], s21 offen nt
  v_permlane16_swap_b32 v132, v148
  v_permlane16_swap_b32 v133, v149
  v_pk_add_f32 v[132:133], v[132:133], v[148:149]
  s_nop 1
  v_add_f32_dpp v132, v132, v132 quad_perm:[1,0,3,2] row_mask:0xf bank_mask:0xf
  v_add_f32_dpp v133, v133, v133 quad_perm:[1,0,3,2] row_mask:0xf bank_mask:0xf
  s_nop 0
  v_add_f32_dpp v132, v132, v132 quad_perm:[2,3,0,1] row_mask:0xf bank_mask:0xf
  v_add_f32_dpp v133, v133, v133 quad_perm:[2,3,0,1] row_mask:0xf bank_mask:0xf
  s_nop 0
  v_add_f32_dpp v132, v132, v132 row_half_mirror row_mask:0xf bank_mask:0xf
  v_add_f32_dpp v133, v133, v133 row_half_mirror row_mask:0xf bank_mask:0xf
  s_nop 0
  v_add_f32_dpp v132, v132, v132 row_mirror row_mask:0xf bank_mask:0xf
  v_add_f32_dpp v133, v133, v133 row_mirror row_mask:0xf bank_mask:0xf
  v_max_f32 v160, v132, v133
  v_dot2_f32_bf16 v134, v52, v120, 0
  v_dot2_f32_bf16 v134, v53, v121, v134
  v_dot2_f32_bf16 v134, v54, v122, v134
  v_dot2_f32_bf16 v134, v55, v123, v134
  s_waitcnt vmcnt(4)
  s_cbranch_vccnz L_bz62
  s_waitcnt vmcnt(2)
  s_cbranch_scc1 L_bz62
  s_waitcnt vmcnt(1)
L_bz62:
  buffer_load_dwordx4 v[84:87], v1, s[72:75], s22 offen nt
  s_memrealtime s[82:83]
  v_dot2_f32_bf16 v148, v56, v120, 0
  v_dot2_f32_bf16 v148, v57, v121, v148
  v_dot2_f32_bf16 v148, v58, v122, v148
  v_dot2_f32_bf16 v148, v59, v123, v148
  s_waitcnt vmcnt(4)
  s_cbranch_vccnz L_bz63
  s_waitcnt vmcnt(2)
  s_cbranch_scc1 L_bz63
  s_waitcnt vmcnt(1)
L_bz63:
  buffer_load_dwordx4 v[88:91], v1, s[72:75], s23 offen nt
  s_waitcnt lgkmcnt(0)
  s_sub_u32 s80, s82, s54
  s_sub_u32 s80, s80, 2289
  s_cmp_gt_i32 s80, 80
  s_cselect_b64 vcc, 1, 0
  s_cmp_gt_i32 s80, 0
  v_dot2_f32_bf16 v135, v60, v120, 0
  v_dot2_f32_bf16 v135, v61, v121, v135
  v_dot2_f32_bf16 v135, v62, v122, v135
  v_dot2_f32_bf16 v135, v63, v123, v135
  s_waitcnt vmcnt(4)
  s_cbranch_vccnz L_bz64
  s_waitcnt vmcnt(2)
  s_cbranch_scc1 L_bz64
  s_waitcnt vmcnt(1)
L_bz64:
  buffer_load_dwordx4 v[92:95], v1, s[72:75], s24 offen nt
  v_dot2_f32_bf16 v149, v64, v120, 0
  v_dot2_f32_bf16 v149, v65, v121, v149
  v_dot2_f32_bf16 v149, v66, v122, v149
  v_dot2_f32_bf16 v149, v67, v123, v149
  s_waitcnt vmcnt(4)
  s_cbranch_vccnz L_bz65
  s_waitcnt vmcnt(2)
  s_cbranch_scc1 L_bz65
  s_waitcnt vmcnt(1)
L_bz65:
  buffer_load_dwordx4 v[96:99], v1, s[72:75], s25 offen nt
  v_permlane16_swap_b32 v134, v148
  v_permlane16_swap_b32 v135, v149
  v_pk_add_f32 v[134:135], v[134:135], v[148:149]
  s_nop 1
  v_add_f32_dpp v134, v134, v134 quad_perm:[1,0,3,2] row_mask:0xf bank_mask:0xf
  v_add_f32_dpp v135, v135, v135 quad_perm:[1,0,3,2] row_mask:0xf bank_mask:0xf
  s_nop 0
  v_add_f32_dpp v134, v134, v134 quad_perm:[2,3,0,1] row_mask:0xf bank_mask:0xf
  v_add_f32_dpp v135, v135, v135 quad_perm:[2,3,0,1] row_mask:0xf bank_mask:0xf
  s_nop 0
  v_add_f32_dpp v134, v134, v134 row_half_mirror row_mask:0xf bank_mask:0xf
  v_add_f32_dpp v135, v135, v135 row_half_mirror row_mask:0xf bank_mask:0xf
  s_nop 0
  v_add_f32_dpp v134, v134, v134 row_mirror row_mask:0xf bank_mask:0xf
  v_add_f32_dpp v135, v135, v135 row_mirror row_mask:0xf bank_mask:0xf
  v_max3_f32 v160, v134, v135, v160
  v_dot2_f32_bf16 v136, v68, v120, 0
  v_dot2_f32_bf16 v136, v69, v121, v136
  v_dot2_f32_bf16 v136, v70, v122, v136
  v_dot2_f32_bf16 v136, v71, v123, v136
  s_waitcnt vmcnt(4)
  s_cbranch_vccnz L_bz66
  s_waitcnt vmcnt(2)
  s_cbranch_scc1 L_bz66
  s_waitcnt vmcnt(1)
L_bz66:
  buffer_load_dwordx4 v[100:103], v1, s[76:79], s60 offen nt
  s_memrealtime s[82:83]
  v_dot2_f32_bf16 v148, v72, v120, 0
  v_dot2_f32_bf16 v148, v73, v121, v148
  v_dot2_f32_bf16 v148, v74, v122, v148
  v_dot2_f32_bf16 v148, v75, v123, v148
  s_waitcnt vmcnt(4)
  s_cbranch_vccnz L_bz67
  s_waitcnt vmcnt(2)
  s_cbranch_scc1 L_bz67
  s_waitcnt vmcnt(1)
L_bz67:
  buffer_load_dwordx4 v[104:107], v1, s[76:79], s61 offen nt
  s_waitcnt lgkmcnt(0)
  s_sub_u32 s80, s82, s54
  s_sub_u32 s80, s80, 2396
  s_cmp_gt_i32 s80, 80
  s_cselect_b64 vcc, 1, 0
  s_cmp_gt_i32 s80, 0
  v_dot2_f32_bf16 v137, v76, v120, 0
  v_dot2_f32_bf16 v137, v77, v121, v137
  v_dot2_f32_bf16 v137, v78, v122, v137
  v_dot2_f32_bf16 v137, v79, v123, v137
  s_waitcnt vmcnt(4)
  s_cbranch_vccnz L_bz68
  s_waitcnt vmcnt(2)
  s_cbranch_scc1 L_bz68
  s_waitcnt vmcnt(1)
L_bz68:
  buffer_load_dwordx4 v[108:111], v1, s[76:79], s68 offen nt
  v_dot2_f32_bf16 v149, v80, v120, 0
  v_dot2_f32_bf16 v149, v81, v121, v149
  v_dot2_f32_bf16 v149, v82, v122, v149
  v_dot2_f32_bf16 v149, v83, v123, v149
  s_waitcnt vmcnt(4)
  s_cbranch_vccnz L_bz69
  s_waitcnt vmcnt(2)
  s_cbranch_scc1 L_bz69
  s_waitcnt vmcnt(1)
L_bz69:
  buffer_load_dwordx4 v[112:115], v1, s[76:79], s69 offen nt
  v_permlane16_swap_b32 v136, v148
  v_permlane16_swap_b32 v137, v149
  v_pk_add_f32 v[136:137], v[136:137], v[148:149]
  s_nop 1
  v_add_f32_dpp v136, v136, v136 quad_perm:[1,0,3,2] row_mask:0xf bank_mask:0xf
  v_add_f32_dpp v137, v137, v137 quad_perm:[1,0,3,2] row_mask:0xf bank_mask:0xf
  s_nop 0
  v_add_f32_dpp v136, v136, v136 quad_perm:[2,3,0,1] row_mask:0xf bank_mask:0xf
  v_add_f32_dpp v137, v137, v137 quad_perm:[2,3,0,1] row_mask:0xf bank_mask:0xf
  s_nop 0
  v_add_f32_dpp v136, v136, v136 row_half_mirror row_mask:0xf bank_mask:0xf
  v_add_f32_dpp v137, v137, v137 row_half_mirror row_mask:0xf bank_mask:0xf
  s_nop 0
  v_add_f32_dpp v136, v136, v136 row_mirror row_mask:0xf bank_mask:0xf
  v_add_f32_dpp v137, v137, v137 row_mirror row_mask:0xf bank_mask:0xf
  v_max3_f32 v160, v136, v137, v160
  v_dot2_f32_bf16 v138, v84, v120, 0
  v_dot2_f32_bf16 v138, v85, v121, v138
  v_dot2_f32_bf16 v138, v86, v122, v138
  v_dot2_f32_bf16 v138, v87, v123, v138
  s_waitcnt vmcnt(4)
  s_cbranch_vccnz L_bz70
  s_waitcnt vmcnt(2)
  s_cbranch_scc1 L_bz70
  s_waitcnt vmcnt(1)
L_bz70:
  buffer_load_dwordx4 v[4:7], v1, s[76:79], s14 offen nt
  s_memrealtime s[82:83]
  v_dot2_f32_bf16 v148, v88, v120, 0
  v_dot2_f32_bf16 v148, v89, v121, v148
  v_dot2_f32_bf16 v148, v90, v122, v148
  v_dot2_f32_bf16 v148, v91, v123, v148
  s_waitcnt vmcnt(4)
  s_cbranch_vccnz L_bz71
  s_waitcnt vmcnt(2)
  s_cbranch_scc1 L_bz71
  s_waitcnt vmcnt(1)
L_bz71:
  buffer_load_dwordx4 v[8:11], v1, s[76:79], s15 offen nt
  s_waitcnt lgkmcnt(0)
  s_sub_u32 s80, s82, s54
  s_sub_u32 s80, s80, 2502
  s_cmp_gt_i32 s80, 80
  s_cselect_b64 vcc, 1, 0
  s_cmp_gt_i32 s80, 0
  v_dot2_f32_bf16 v139, v92, v120, 0
  v_dot2_f32_bf16 v139, v93, v121, v139
  v_dot2_f32_bf16 v139, v94, v122, v139
  v_dot2_f32_bf16 v139, v95, v123, v139
  s_waitcnt vmcnt(4)
  s_cbranch_vccnz L_bz72
  s_waitcnt vmcnt(2)
  s_cbranch_scc1 L_bz72
  s_waitcnt vmcnt(1)
L_bz72:
  buffer_load_dwordx4 v[12:15], v1, s[76:79], s16 offen nt
  v_dot2_f32_bf16 v149, v96, v120, 0
  v_dot2_f32_bf16 v149, v97, v121, v149
  v_dot2_f32_bf16 v149, v98, v122, v149
  v_dot2_f32_bf16 v149, v99, v123, v149
  s_waitcnt vmcnt(4)
  s_cbranch_vccnz L_bz73
  s_waitcnt vmcnt(2)
  s_cbranch_scc1 L_bz73
  s_waitcnt vmcnt(1)
L_bz73:
  buffer_load_dwordx4 v[16:19], v1, s[76:79], s17 offen nt
  v_permlane16_swap_b32 v138, v148
  v_permlane16_swap_b32 v139, v149
  v_pk_add_f32 v[138:139], v[138:139], v[148:149]
  s_nop 1
  v_add_f32_dpp v138, v138, v138 quad_perm:[1,0,3,2] row_mask:0xf bank_mask:0xf
  v_add_f32_dpp v139, v139, v139 quad_perm:[1,0,3,2] row_mask:0xf bank_mask:0xf
  s_nop 0
  v_add_f32_dpp v138, v138, v138 quad_perm:[2,3,0,1] row_mask:0xf bank_mask:0xf
  v_add_f32_dpp v139, v139, v139 quad_perm:[2,3,0,1] row_mask:0xf bank_mask:0xf
  s_nop 0
  v_add_f32_dpp v138, v138, v138 row_half_mirror row_mask:0xf bank_mask:0xf
  v_add_f32_dpp v139, v139, v139 row_half_mirror row_mask:0xf bank_mask:0xf
  s_nop 0
  v_add_f32_dpp v138, v138, v138 row_mirror row_mask:0xf bank_mask:0xf
  v_add_f32_dpp v139, v139, v139 row_mirror row_mask:0xf bank_mask:0xf
  v_max3_f32 v160, v138, v139, v160
  v_mov_b32 v148, v160
  s_nop 1
  v_permlane16_swap_b32 v160, v148
  v_max_f32 v160, v160, v148
  v_mov_b32 v148, v160
  s_nop 1
  v_permlane32_swap_b32 v160, v148
  v_max_f32 v160, v160, v148
  v_mul_f32 v152, s67, v160
  v_fma_f32 v132, v132, s67, -v152
  v_fma_f32 v133, v133, s67, -v152
  v_fma_f32 v134, v134, s67, -v152
  v_fma_f32 v135, v135, s67, -v152
  v_fma_f32 v136, v136, s67, -v152
  v_fma_f32 v137, v137, s67, -v152
  v_fma_f32 v138, v138, s67, -v152
  v_fma_f32 v139, v139, s67, -v152
  v_exp_f32 v132, v132
  v_exp_f32 v133, v133
  v_exp_f32 v134, v134
  v_exp_f32 v135, v135
  v_exp_f32 v136, v136
  v_exp_f32 v137, v137
  v_exp_f32 v138, v138
  v_exp_f32 v139, v139
  v_pk_add_f32 v[148:149], v[132:133], v[134:135]
  v_pk_add_f32 v[156:157], v[136:137], v[138:139]
  v_pk_add_f32 v[148:149], v[148:149], v[156:157]
  v_mov_b64 v[156:157], v[132:133]
  s_nop 1
  v_permlane16_swap_b32 v132, v156
  v_permlane16_swap_b32 v133, v157
  v_permlane16_swap_b32 v148, v149
  v_add_f32 v148, v148, v149
  v_mov_b32 v149, v148
  s_nop 1
  v_permlane16_swap_b32 v148, v149
  v_add_f32 v148, v148, v149
  v_mov_b32 v149, v148
  s_nop 1
  v_permlane32_swap_b32 v148, v149
  v_add_f32 v153, v148, v149
  s_mov_b64 exec, 1
  ds_write_b64 v164, v[152:153] offset:4416
  ds_add_rtn_u32 v160, v162, v3 offset:4124
  s_mov_b64 exec, -1
  ds_read_b128 v[124:127], v162 offset:4416
  ds_read_b128 v[128:131], v162 offset:4432
  ds_read_b128 v[140:143], v162 offset:4448
  ds_read_b128 v[144:147], v162 offset:4464
  s_waitcnt lgkmcnt(0)
  v_readfirstlane_b32 s64, v160
  s_nop 0
  s_cmp_lg_u32 s64, 7
  s_cbranch_scc1 L_nowt
  v_max3_f32 v165, v124, v126, v128
  v_max3_f32 v166, v130, v140, v142
  v_max3_f32 v165, v165, v144, v146
  v_max_f32 v165, v165, v166
  v_sub_f32 v124, v124, v165
  v_sub_f32 v126, v126, v165
  v_sub_f32 v128, v128, v165
  v_sub_f32 v130, v130, v165
  v_sub_f32 v140, v140, v165
  v_sub_f32 v142, v142, v165
  v_sub_f32 v144, v144, v165
  v_sub_f32 v146, v146, v165
  v_exp_f32 v124, v124
  v_exp_f32 v126, v126
  v_exp_f32 v128, v128
  v_exp_f32 v130, v130
  v_exp_f32 v140, v140
  v_exp_f32 v142, v142
  v_exp_f32 v144, v144
  v_exp_f32 v146, v146
  v_mul_f32 v166, v124, v125
  v_mul_f32 v167, v126, v127
  v_fmac_f32 v166, v128, v129
  v_fmac_f32 v167, v130, v131
  v_fmac_f32 v166, v140, v141
  v_fmac_f32 v167, v142, v143
  v_fmac_f32 v166, v144, v145
  v_fmac_f32 v167, v146, v147
  v_add_f32 v166, v166, v167
  v_log_f32 v160, v166
  v_rcp_f32 v166, v166
  v_add_f32 v160, v160, v165
  v_mul_f32 v148, v124, v166
  v_mul_f32 v149, v126, v166
  v_mul_f32 v150, v128, v166
  v_mul_f32 v151, v130, v166
  v_mul_f32 v152, v140, v166
  v_mul_f32 v153, v142, v166
  v_mul_f32 v154, v144, v166
  v_mul_f32 v155, v146, v166
  v_mov_b32 v161, s53
  s_mov_b64 exec, 1
  ds_write_b128 v162, v[148:151] offset:4224
  ds_write_b128 v162, v[152:155] offset:4240
  ds_write_b32 v162, v3 offset:4256
  s_cmp_eq_u32 s71, 0
  s_cbranch_scc1 L_dp74
  buffer_store_dwordx2 v[160:161], v162, s[56:59], s12 offen sc1
  s_branch L_dq74
L_dp74:
  buffer_store_dwordx2 v[160:161], v162, s[56:59], s12 offen
L_dq74:
  s_mov_b64 exec, -1
L_nowt:
  s_cmp_gt_i32 s80, 80
  s_cselect_b64 vcc, 1, 0
  s_cmp_gt_i32 s80, 0
  v_lshlrev_b32 v148, 16, v100
  v_and_b32 v149, s66, v100
  v_lshlrev_b32 v150, 16, v101
  v_and_b32 v151, s66, v101
  v_lshlrev_b32 v152, 16, v102
  v_and_b32 v153, s66, v102
  v_lshlrev_b32 v154, 16, v103
  v_and_b32 v155, s66, v103
  s_waitcnt vmcnt(4)
  s_cbranch_vccnz L_bz75
  s_waitcnt vmcnt(2)
  s_cbranch_scc1 L_bz75
  s_waitcnt vmcnt(1)
L_bz75:
  buffer_load_dwordx4 v[20:23], v1, s[76:79], s18 offen nt
  s_memrealtime s[82:83]
  v_pk_mul_f32 v[116:117], v[148:149], v[132:133] op_sel_hi:[1,0]
  v_pk_mul_f32 v[118:119], v[150:151], v[132:133] op_sel_hi:[1,0]
  v_pk_mul_f32 v[120:121], v[152:153], v[132:133] op_sel_hi:[1,0]
  v_pk_mul_f32 v[122:123], v[154:155], v[132:133] op_sel_hi:[1,0]
  v_lshlrev_b32 v148, 16, v104
  v_and_b32 v149, s66, v104
  v_lshlrev_b32 v150, 16, v105
  v_and_b32 v151, s66, v105
  v_lshlrev_b32 v152, 16, v106
  v_and_b32 v153, s66, v106
  v_lshlrev_b32 v154, 16, v107
  v_and_b32 v155, s66, v107
  s_waitcnt vmcnt(4)
  s_cbranch_vccnz L_bz76
  s_waitcnt vmcnt(2)
  s_cbranch_scc1 L_bz76
  s_waitcnt vmcnt(1)
L_bz76:
  buffer_load_dwordx4 v[24:27], v1, s[76:79], s19 offen nt
  s_waitcnt lgkmcnt(0)
  s_sub_u32 s80, s82, s54
  s_sub_u32 s80, s80, 2609
  s_cmp_gt_i32 s80, 80
  s_cselect_b64 vcc, 1, 0
  s_cmp_gt_i32 s80, 0
  v_pk_fma_f32 v[116:117], v[148:149], v[156:157], v[116:117] op_sel_hi:[1,0,1]
  v_pk_fma_f32 v[118:119], v[150:151], v[156:157], v[118:119] op_sel_hi:[1,0,1]
  v_pk_fma_f32 v[120:121], v[152:153], v[156:157], v[120:121] op_sel_hi:[1,0,1]
  v_pk_fma_f32 v[122:123], v[154:155], v[156:157], v[122:123] op_sel_hi:[1,0,1]
  v_lshlrev_b32 v148, 16, v108
  v_and_b32 v149, s66, v108
  v_lshlrev_b32 v150, 16, v109
  v_and_b32 v151, s66, v109
  v_lshlrev_b32 v152, 16, v110
  v_and_b32 v153, s66, v110
  v_lshlrev_b32 v154, 16, v111
  v_and_b32 v155, s66, v111
  s_waitcnt vmcnt(4)
  s_cbranch_vccnz L_bz77
  s_waitcnt vmcnt(2)
  s_cbranch_scc1 L_bz77
  s_waitcnt vmcnt(1)
L_bz77:
  buffer_load_dwordx4 v[28:31], v1, s[76:79], s20 offen nt
  v_pk_fma_f32 v[116:117], v[148:149], v[132:133], v[116:117] op_sel:[0,1,0]
  v_pk_fma_f32 v[118:119], v[150:151], v[132:133], v[118:119] op_sel:[0,1,0]
  v_pk_fma_f32 v[120:121], v[152:153], v[132:133], v[120:121] op_sel:[0,1,0]
  v_pk_fma_f32 v[122:123], v[154:155], v[132:133], v[122:123] op_sel:[0,1,0]
  v_lshlrev_b32 v148, 16, v112
  v_and_b32 v149, s66, v112
  v_lshlrev_b32 v150, 16, v113
  v_and_b32 v151, s66, v113
  v_lshlrev_b32 v152, 16, v114
  v_and_b32 v153, s66, v114
  v_lshlrev_b32 v154, 16, v115
  v_and_b32 v155, s66, v115
  s_waitcnt vmcnt(4)
  s_cbranch_vccnz L_bz78
  s_waitcnt vmcnt(2)
  s_cbranch_scc1 L_bz78
  s_waitcnt vmcnt(1)
L_bz78:
  buffer_load_dwordx4 v[32:35], v1, s[76:79], s21 offen nt
  v_pk_fma_f32 v[116:117], v[148:149], v[156:157], v[116:117] op_sel:[0,1,0]
  v_pk_fma_f32 v[118:119], v[150:151], v[156:157], v[118:119] op_sel:[0,1,0]
  v_pk_fma_f32 v[120:121], v[152:153], v[156:157], v[120:121] op_sel:[0,1,0]
  v_pk_fma_f32 v[122:123], v[154:155], v[156:157], v[122:123] op_sel:[0,1,0]
  v_mov_b64 v[156:157], v[134:135]
  s_nop 1
  v_permlane16_swap_b32 v134, v156
  v_permlane16_swap_b32 v135, v157
  v_lshlrev_b32 v148, 16, v4
  v_and_b32 v149, s66, v4
  v_lshlrev_b32 v150, 16, v5
  v_and_b32 v151, s66, v5
  v_lshlrev_b32 v152, 16, v6
  v_and_b32 v153, s66, v6
  v_lshlrev_b32 v154, 16, v7
  v_and_b32 v155, s66, v7
  s_waitcnt vmcnt(4)
  s_cbranch_vccnz L_bz79
  s_waitcnt vmcnt(2)
  s_cbranch_scc1 L_bz79
  s_waitcnt vmcnt(1)
L_bz79:
  buffer_load_dwordx4 v[36:39], v1, s[76:79], s22 offen nt
  s_memrealtime s[82:83]
  v_pk_fma_f32 v[116:117], v[148:149], v[134:135], v[116:117] op_sel_hi:[1,0,1]
  v_pk_fma_f32 v[118:119], v[150:151], v[134:135], v[118:119] op_sel_hi:[1,0,1]
  v_pk_fma_f32 v[120:121], v[152:153], v[134:135], v[120:121] op_sel_hi:[1,0,1]
  v_pk_fma_f32 v[122:123], v[154:155], v[134:135], v[122:123] op_sel_hi:[1,0,1]
  v_lshlrev_b32 v148, 16, v8
  v_and_b32 v149, s66, v8
  v_lshlrev_b32 v150, 16, v9
  v_and_b32 v151, s66, v9
  v_lshlrev_b32 v152, 16, v10
  v_and_b32 v153, s66, v10
  v_lshlrev_b32 v154, 16, v11
  v_and_b32 v155, s66, v11
  s_waitcnt vmcnt(4)
  s_cbranch_vccnz L_bz80
  s_waitcnt vmcnt(2)
  s_cbranch_scc1 L_bz80
  s_waitcnt vmcnt(1)
L_bz80:
  buffer_load_dwordx4 v[40:43], v1, s[76:79], s23 offen nt
  s_waitcnt lgkmcnt(0)
  s_sub_u32 s80, s82, s54
  s_sub_u32 s80, s80, 2716
  s_cmp_gt_i32 s80, 80
  s_cselect_b64 vcc, 1, 0
  s_cmp_gt_i32 s80, 0
  v_pk_fma_f32 v[116:117], v[148:149], v[156:157], v[116:117] op_sel_hi:[1,0,1]
  v_pk_fma_f32 v[118:119], v[150:151], v[156:157], v[118:119] op_sel_hi:[1,0,1]
  v_pk_fma_f32 v[120:121], v[152:153], v[156:157], v[120:121] op_sel_hi:[1,0,1]
  v_pk_fma_f32 v[122:123], v[154:155], v[156:157], v[122:123] op_sel_hi:[1,0,1]
  v_lshlrev_b32 v148, 16, v12
  v_and_b32 v149, s66, v12
  v_lshlrev_b32 v150, 16, v13
  v_and_b32 v151, s66, v13
  v_lshlrev_b32 v152, 16, v14
  v_and_b32 v153, s66, v14
  v_lshlrev_b32 v154, 16, v15
  v_and_b32 v155, s66, v15
  s_waitcnt vmcnt(4)
  s_cbranch_vccnz L_bz81
  s_waitcnt vmcnt(2)
  s_cbranch_scc1 L_bz81
  s_waitcnt vmcnt(1)
L_bz81:
  buffer_load_dwordx4 v[44:47], v1, s[76:79], s24 offen nt
  v_pk_fma_f32 v[116:117], v[148:149], v[134:135], v[116:117] op_sel:[0,1,0]
  v_pk_fma_f32 v[118:119], v[150:151], v[134:135], v[118:119] op_sel:[0,1,0]
  v_pk_fma_f32 v[120:121], v[152:153], v[134:135], v[120:121] op_sel:[0,1,0]
  v_pk_fma_f32 v[122:123], v[154:155], v[134:135], v[122:123] op_sel:[0,1,0]
  v_lshlrev_b32 v148, 16, v16
  v_and_b32 v149, s66, v16
  v_lshlrev_b32 v150, 16, v17
  v_and_b32 v151, s66, v17
  v_lshlrev_b32 v152, 16, v18
  v_and_b32 v153, s66, v18
  v_lshlrev_b32 v154, 16, v19
  v_and_b32 v155, s66, v19
  s_waitcnt vmcnt(4)
  s_cbranch_vccnz L_bz82
  s_waitcnt vmcnt(2)
  s_cbranch_scc1 L_bz82
  s_waitcnt vmcnt(1)
L_bz82:
  buffer_load_dwordx4 v[48:51], v1, s[76:79], s25 offen nt
  v_pk_fma_f32 v[116:117], v[148:149], v[156:157], v[116:117] op_sel:[0,1,0]
  v_pk_fma_f32 v[118:119], v[150:151], v[156:157], v[118:119] op_sel:[0,1,0]
  v_pk_fma_f32 v[120:121], v[152:153], v[156:157], v[120:121] op_sel:[0,1,0]
  v_pk_fma_f32 v[122:123], v[154:155], v[156:157], v[122:123] op_sel:[0,1,0]
  v_mov_b64 v[156:157], v[136:137]
  s_nop 1
  v_permlane16_swap_b32 v136, v156
  v_permlane16_swap_b32 v137, v157
  v_lshlrev_b32 v148, 16, v20
  v_and_b32 v149, s66, v20
  v_lshlrev_b32 v150, 16, v21
  v_and_b32 v151, s66, v21
  v_lshlrev_b32 v152, 16, v22
  v_and_b32 v153, s66, v22
  v_lshlrev_b32 v154, 16, v23
  v_and_b32 v155, s66, v23
  v_pk_fma_f32 v[116:117], v[148:149], v[136:137], v[116:117] op_sel_hi:[1,0,1]
  v_pk_fma_f32 v[118:119], v[150:151], v[136:137], v[118:119] op_sel_hi:[1,0,1]
  v_pk_fma_f32 v[120:121], v[152:153], v[136:137], v[120:121] op_sel_hi:[1,0,1]
  v_pk_fma_f32 v[122:123], v[154:155], v[136:137], v[122:123] op_sel_hi:[1,0,1]
  v_lshlrev_b32 v148, 16, v24
  v_and_b32 v149, s66, v24
  v_lshlrev_b32 v150, 16, v25
  v_and_b32 v151, s66, v25
  v_lshlrev_b32 v152, 16, v26
  v_and_b32 v153, s66, v26
  v_lshlrev_b32 v154, 16, v27
  v_and_b32 v155, s66, v27
  v_pk_fma_f32 v[116:117], v[148:149], v[156:157], v[116:117] op_sel_hi:[1,0,1]
  v_pk_fma_f32 v[118:119], v[150:151], v[156:157], v[118:119] op_sel_hi:[1,0,1]
  v_pk_fma_f32 v[120:121], v[152:153], v[156:157], v[120:121] op_sel_hi:[1,0,1]
  v_pk_fma_f32 v[122:123], v[154:155], v[156:157], v[122:123] op_sel_hi:[1,0,1]
  v_lshlrev_b32 v148, 16, v28
  v_and_b32 v149, s66, v28
  v_lshlrev_b32 v150, 16, v29
  v_and_b32 v151, s66, v29
  v_lshlrev_b32 v152, 16, v30
  v_and_b32 v153, s66, v30
  v_lshlrev_b32 v154, 16, v31
  v_and_b32 v155, s66, v31
  v_pk_fma_f32 v[116:117], v[148:149], v[136:137], v[116:117] op_sel:[0,1,0]
  v_pk_fma_f32 v[118:119], v[150:151], v[136:137], v[118:119] op_sel:[0,1,0]
  v_pk_fma_f32 v[120:121], v[152:153], v[136:137], v[120:121] op_sel:[0,1,0]
  v_pk_fma_f32 v[122:123], v[154:155], v[136:137], v[122:123] op_sel:[0,1,0]
  s_waitcnt vmcnt(4)
  v_lshlrev_b32 v148, 16, v32
  v_and_b32 v149, s66, v32
  v_lshlrev_b32 v150, 16, v33
  v_and_b32 v151, s66, v33
  v_lshlrev_b32 v152, 16, v34
  v_and_b32 v153, s66, v34
  v_lshlrev_b32 v154, 16, v35
  v_and_b32 v155, s66, v35
  v_pk_fma_f32 v[116:117], v[148:149], v[156:157], v[116:117] op_sel:[0,1,0]
  v_pk_fma_f32 v[118:119], v[150:151], v[156:157], v[118:119] op_sel:[0,1,0]
  v_pk_fma_f32 v[120:121], v[152:153], v[156:157], v[120:121] op_sel:[0,1,0]
  v_pk_fma_f32 v[122:123], v[154:155], v[156:157], v[122:123] op_sel:[0,1,0]
  v_mov_b64 v[156:157], v[138:139]
  s_nop 1
  v_permlane16_swap_b32 v138, v156
  v_permlane16_swap_b32 v139, v157
  s_mov_b32 s65, 524288
L_wt:
  ds_read_b32 v165, v162 offset:4256
  ds_read_b128 v[140:143], v162 offset:4224
  ds_read_b128 v[144:147], v162 offset:4240
  v_mov_b32 v126, s53
  v_mov_b32 v127, s53
  s_waitcnt lgkmcnt(0)
  v_cmp_ne_u32 vcc, 1, v165
  s_cbranch_vccz L_wtok
  s_sub_u32 s65, s65, 1
  s_cbranch_scc0 L_wt
L_wtok:
  s_waitcnt vmcnt(3)
  v_lshlrev_b32 v148, 16, v36
  v_and_b32 v149, s66, v36
  v_lshlrev_b32 v150, 16, v37
  v_and_b32 v151, s66, v37
  v_lshlrev_b32 v152, 16, v38
  v_and_b32 v153, s66, v38
  v_lshlrev_b32 v154, 16, v39
  v_and_b32 v155, s66, v39
  v_pk_fma_f32 v[116:117], v[148:149], v[138:139], v[116:117] op_sel_hi:[1,0,1]
  v_pk_fma_f32 v[118:119], v[150:151], v[138:139], v[118:119] op_sel_hi:[1,0,1]
  v_pk_fma_f32 v[120:121], v[152:153], v[138:139], v[120:121] op_sel_hi:[1,0,1]
  v_pk_fma_f32 v[122:123], v[154:155], v[138:139], v[122:123] op_sel_hi:[1,0,1]
  s_waitcnt vmcnt(2)
  v_lshlrev_b32 v148, 16, v40
  v_and_b32 v149, s66, v40
  v_lshlrev_b32 v150, 16, v41
  v_and_b32 v151, s66, v41
  v_lshlrev_b32 v152, 16, v42
  v_and_b32 v153, s66, v42
  v_lshlrev_b32 v154, 16, v43
  v_and_b32 v155, s66, v43
  v_pk_fma_f32 v[116:117], v[148:149], v[156:157], v[116:117] op_sel_hi:[1,0,1]
  v_pk_fma_f32 v[118:119], v[150:151], v[156:157], v[118:119] op_sel_hi:[1,0,1]
  v_pk_fma_f32 v[120:121], v[152:153], v[156:157], v[120:121] op_sel_hi:[1,0,1]
  v_pk_fma_f32 v[122:123], v[154:155], v[156:157], v[122:123] op_sel_hi:[1,0,1]
  s_waitcnt vmcnt(1)
  v_lshlrev_b32 v148, 16, v44
  v_and_b32 v149, s66, v44
  v_lshlrev_b32 v150, 16, v45
  v_and_b32 v151, s66, v45
  v_lshlrev_b32 v152, 16, v46
  v_and_b32 v153, s66, v46
  v_lshlrev_b32 v154, 16, v47
  v_and_b32 v155, s66, v47
  v_pk_fma_f32 v[116:117], v[148:149], v[138:139], v[116:117] op_sel:[0,1,0]
  v_pk_fma_f32 v[118:119], v[150:151], v[138:139], v[118:119] op_sel:[0,1,0]
  v_pk_fma_f32 v[120:121], v[152:153], v[138:139], v[120:121] op_sel:[0,1,0]
  v_pk_fma_f32 v[122:123], v[154:155], v[138:139], v[122:123] op_sel:[0,1,0]
  s_waitcnt vmcnt(0)
  v_lshlrev_b32 v148, 16, v48
  v_and_b32 v149, s66, v48
  v_lshlrev_b32 v150, 16, v49
  v_and_b32 v151, s66, v49
  v_lshlrev_b32 v152, 16, v50
  v_and_b32 v153, s66, v50
  v_lshlrev_b32 v154, 16, v51
  v_and_b32 v155, s66, v51
  v_pk_fma_f32 v[116:117], v[148:149], v[156:157], v[116:117] op_sel:[0,1,0]
  v_pk_fma_f32 v[118:119], v[150:151], v[156:157], v[118:119] op_sel:[0,1,0]
  v_pk_fma_f32 v[120:121], v[152:153], v[156:157], v[120:121] op_sel:[0,1,0]
  v_pk_fma_f32 v[122:123], v[154:155], v[156:157], v[122:123] op_sel:[0,1,0]
  s_nop 0
  v_permlane32_swap_b32 v116, v120
  v_permlane32_swap_b32 v117, v121
  v_permlane32_swap_b32 v118, v122
  v_permlane32_swap_b32 v119, v123
  v_pk_add_f32 v[116:117], v[116:117], v[120:121]
  v_pk_add_f32 v[118:119], v[118:119], v[122:123]
  ds_write_b128 v163, v[116:119] offset:13312
  s_mov_b64 exec, 1
  ds_add_rtn_u32 v148, v162, v3 offset:4120
  s_mov_b64 exec, -1
  ds_read_b128 v[4:7], v1 offset:13312
  ds_read_b128 v[8:11], v1 offset:14336
  ds_read_b128 v[12:15], v1 offset:15360
  ds_read_b128 v[16:19], v1 offset:16384
  ds_read_b128 v[20:23], v1 offset:17408
  ds_read_b128 v[24:27], v1 offset:18432
  ds_read_b128 v[28:31], v1 offset:19456
  ds_read_b128 v[32:35], v1 offset:20480
  s_waitcnt lgkmcnt(8)
  v_readfirstlane_b32 s64, v148
  s_nop 0
  s_cmp_lg_u32 s64, 7
  s_cbranch_scc1 L_end
  s_waitcnt lgkmcnt(6)
  v_pk_mul_f32 v[132:133], v[4:5], v[140:141] op_sel_hi:[1,0]
  v_pk_mul_f32 v[134:135], v[6:7], v[140:141] op_sel_hi:[1,0]
  v_pk_fma_f32 v[132:133], v[8:9], v[140:141], v[132:133] op_sel:[0,1,0]
  v_pk_fma_f32 v[134:135], v[10:11], v[140:141], v[134:135] op_sel:[0,1,0]
  s_waitcnt lgkmcnt(4)
  v_pk_fma_f32 v[132:133], v[12:13], v[142:143], v[132:133] op_sel_hi:[1,0,1]
  v_pk_fma_f32 v[134:135], v[14:15], v[142:143], v[134:135] op_sel_hi:[1,0,1]
  v_pk_fma_f32 v[132:133], v[16:17], v[142:143], v[132:133] op_sel:[0,1,0]
  v_pk_fma_f32 v[134:135], v[18:19], v[142:143], v[134:135] op_sel:[0,1,0]
  s_waitcnt lgkmcnt(2)
  v_pk_fma_f32 v[132:133], v[20:21], v[144:145], v[132:133] op_sel_hi:[1,0,1]
  v_pk_fma_f32 v[134:135], v[22:23], v[144:145], v[134:135] op_sel_hi:[1,0,1]
  v_pk_fma_f32 v[132:133], v[24:25], v[144:145], v[132:133] op_sel:[0,1,0]
  v_pk_fma_f32 v[134:135], v[26:27], v[144:145], v[134:135] op_sel:[0,1,0]
  s_waitcnt lgkmcnt(0)
  v_pk_fma_f32 v[132:133], v[28:29], v[146:147], v[132:133] op_sel_hi:[1,0,1]
  v_pk_fma_f32 v[134:135], v[30:31], v[146:147], v[134:135] op_sel_hi:[1,0,1]
  v_pk_fma_f32 v[132:133], v[32:33], v[146:147], v[132:133] op_sel:[0,1,0]
  v_pk_fma_f32 v[134:135], v[34:35], v[146:147], v[134:135] op_sel:[0,1,0]
  v_cvt_pk_bf16_f32 v124, v132, v133
  v_cvt_pk_bf16_f32 v125, v134, v135
  s_cmp_eq_u32 s71, 0
  s_cbranch_scc1 L_dp83
  buffer_store_dwordx4 v[124:127], v1, s[56:59], s70 offen sc1
  s_branch L_dq83
L_dp83:
  buffer_store_dwordx4 v[124:127], v1, s[56:59], s70 offen
L_dq83:
  s_endpgm
L_serv:
  s_setprio 3
  s_lshr_b32 s4, s5, 3
  s_lshl_b32 s6, s4, 3
  s_add_u32 s6, s6, s3
  s_lshl_b32 s7, s3, 1
  s_add_u32 s7, s7, s4
  s_sub_u32 s7, s7, 2
  s_cmp_lt_u32 s4, 2
  s_cselect_b32 s6, s6, s7
  s_lshl_b32 s7, s6, 9
  s_and_b32 s64, s5, 6
  s_lshl_b32 s64, s64, 6
  s_add_u32 s7, s7, s64
  s_and_b32 s64, s5, 1
  s_mul_i32 s65, s64, 1835008
  s_add_u32 s7, s7, s65
  s_mul_i32 s64, s64, 448
  v_lshrrev_b32 v2, 3, v0
  v_and_b32 v3, 7, v0
  v_lshlrev_b32 v4, 16, v2
  v_lshl_add_u32 v4, v3, 4, v4
  v_add_u32 v4, s7, v4
  v_lshlrev_b32 v5, 4, v2
  v_add_u32 v5, s64, v5
  v_mov_b32 v6, 0x40000000
  v_cmp_gt_u32 vcc, 224, v0
  s_nop 1
  v_cndmask_b32 v4, v6, v4, vcc
  v_cndmask_b32 v5, v6, v5, vcc
  s_mov_b64 s[80:81], vcc
  s_mov_b32 s38, 3670016
  s_mov_b32 s39, 0x20000
  s_mov_b32 s42, 3670016
  s_mov_b32 s43, 0x20000
  s_movk_i32 s46, 896
  s_mov_b32 s47, 0x20000
  s_movk_i32 s50, 896
  s_mov_b32 s51, 0x20000
  v_lshlrev_b32 v6, 3, v0
  v_mov_b32 v8, 0
  v_mov_b32 v9, 0
  ds_write_b64 v6, v[8:9] offset:2048
  ds_write_b64 v1, v[8:9] offset:4096
  ds_write_b64 v1, v[8:9] offset:4104
  s_cmp_ge_u32 s4, 2
  s_waitcnt lgkmcnt(0)
  s_cselect_b64 s[36:37], s[24:25], s[14:15]
  s_cselect_b64 s[40:41], s[26:27], s[16:17]
  s_mov_b64 s[44:45], s[8:9]
  s_mov_b64 s[48:49], s[28:29]
  s_load_dword s52, s[34:35], 0
  s_mov_b32 s56, s34
  s_mov_b32 s57, s35
  s_mov_b32 s58, 4194304
  s_mov_b32 s59, 0x20000
  buffer_load_dwordx4 v[12:15], v4, s[36:39], 0 offen nt
  s_mov_b32 s65, 8192
  buffer_load_dwordx4 v[16:19], v4, s[36:39], s65 offen nt
  s_mov_b32 s66, 16384
  buffer_load_dwordx4 v[20:23], v4, s[36:39], s66 offen nt
  s_mov_b32 s67, 24576
  buffer_load_dwordx4 v[24:27], v4, s[36:39], s67 offen nt
  s_mov_b32 s68, 32768
  buffer_load_dwordx4 v[28:31], v4, s[36:39], s68 offen nt
  s_mov_b32 s69, 40960
  buffer_load_dwordx4 v[32:35], v4, s[36:39], s69 offen nt
  s_mov_b32 s70, 49152
  buffer_load_dwordx4 v[36:39], v4, s[36:39], s70 offen nt
  s_mov_b32 s71, 57344
  buffer_load_dwordx4 v[40:43], v4, s[36:39], s71 offen nt
  buffer_load_dwordx4 v[44:47], v5, s[44:47], 0 offen
  s_barrier
  v_lshrrev_b32 v7, 6, v0
  v_mul_u32_u24 v7, 28672, v7
  v_add_u32 v7, v7, v1
  v_lshrrev_b32 v7, 1, v7
  s_lshl_b32 s54, s6, 2
  s_bfe_u32 s55, s5, 0x20001
  s_add_u32 s54, s54, s55
  s_mul_i32 s54, s54, 57344
  s_and_b32 s55, s5, 1
  s_lshl_b32 s55, s55, 9
  s_add_u32 s54, s54, s55
  s_mov_b32 s72, 0xffff0000
  s_mov_b32 s73, 0x05040100
  s_mov_b32 s74, 0x07060302
  s_getreg_b32 s75, hwreg(HW_REG_XCC_ID)
  s_and_b32 s75, s75, 15
  v_lshrrev_b32 v60, 4, v0
  v_and_b32 v61, 3, v60
  v_lshrrev_b32 v60, 2, v60
  v_lshlrev_b32 v60, 9, v60
  v_lshl_add_u32 v60, v61, 4, v60
  v_lshl_add_u32 v62, v3, 6, v60
  v_and_b32 v63, 31, v0
  v_lshlrev_b32 v63, 4, v63
  v_mov_b32 v2, 0
  s_waitcnt lgkmcnt(0)
  s_mul_i32 s53, s52, 0x9E3779B1
  s_add_u32 s53, s53, 0x7F4A7C15
  s_andn2_b32 s76, s53, 15
  s_or_b32 s76, s76, s75
  s_waitcnt vmcnt(0)
  v_perm_b32 v48, v16, v12, s73
  v_perm_b32 v49, v16, v12, s74
  v_dot2_f32_bf16 v52, v48, v44, 0
  v_dot2_f32_bf16 v53, v49, v44, 0
  v_perm_b32 v50, v17, v13, s73
  v_perm_b32 v51, v17, v13, s74
  v_dot2_f32_bf16 v54, v50, v44, 0
  v_dot2_f32_bf16 v55, v51, v44, 0
  v_perm_b32 v48, v18, v14, s73
  v_perm_b32 v49, v18, v14, s74
  v_dot2_f32_bf16 v56, v48, v44, 0
  v_dot2_f32_bf16 v57, v49, v44, 0
  v_perm_b32 v50, v19, v15, s73
  v_perm_b32 v51, v19, v15, s74
  v_dot2_f32_bf16 v58, v50, v44, 0
  v_dot2_f32_bf16 v59, v51, v44, 0
  v_perm_b32 v48, v24, v20, s73
  v_perm_b32 v49, v24, v20, s74
  v_dot2_f32_bf16 v52, v48, v45, v52
  v_dot2_f32_bf16 v53, v49, v45, v53
  v_perm_b32 v50, v25, v21, s73
  v_perm_b32 v51, v25, v21, s74
  v_dot2_f32_bf16 v54, v50, v45, v54
  v_dot2_f32_bf16 v55, v51, v45, v55
  v_perm_b32 v48, v26, v22, s73
  v_perm_b32 v49, v26, v22, s74
  v_dot2_f32_bf16 v56, v48, v45, v56
  v_dot2_f32_bf16 v57, v49, v45, v57
  v_perm_b32 v50, v27, v23, s73
  v_perm_b32 v51, v27, v23, s74
  v_dot2_f32_bf16 v58, v50, v45, v58
  v_dot2_f32_bf16 v59, v51, v45, v59
  v_perm_b32 v48, v32, v28, s73
  v_perm_b32 v49, v32, v28, s74
  v_dot2_f32_bf16 v52, v48, v46, v52
  v_dot2_f32_bf16 v53, v49, v46, v53
  v_perm_b32 v50, v33, v29, s73
  v_perm_b32 v51, v33, v29, s74
  v_dot2_f32_bf16 v54, v50, v46, v54
  v_dot2_f32_bf16 v55, v51, v46, v55
  v_perm_b32 v48, v34, v30, s73
  v_perm_b32 v49, v34, v30, s74
  v_dot2_f32_bf16 v56, v48, v46, v56
  v_dot2_f32_bf16 v57, v49, v46, v57
  v_perm_b32 v50, v35, v31, s73
  v_perm_b32 v51, v35, v31, s74
  v_dot2_f32_bf16 v58, v50, v46, v58
  v_dot2_f32_bf16 v59, v51, v46, v59
  v_perm_b32 v48, v40, v36, s73
  v_perm_b32 v49, v40, v36, s74
  v_dot2_f32_bf16 v52, v48, v47, v52
  v_dot2_f32_bf16 v53, v49, v47, v53
  v_perm_b32 v50, v41, v37, s73
  v_perm_b32 v51, v41, v37, s74
  v_dot2_f32_bf16 v54, v50, v47, v54
  v_dot2_f32_bf16 v55, v51, v47, v55
  v_perm_b32 v48, v42, v38, s73
  v_perm_b32 v49, v42, v38, s74
  v_dot2_f32_bf16 v56, v48, v47, v56
  v_dot2_f32_bf16 v57, v49, v47, v57
  v_perm_b32 v50, v43, v39, s73
  v_perm_b32 v51, v43, v39, s74
  v_dot2_f32_bf16 v58, v50, v47, v58
  v_dot2_f32_bf16 v59, v51, v47, v59
  v_permlane32_swap_b32 v52, v56
  v_permlane32_swap_b32 v53, v57
  v_permlane32_swap_b32 v54, v58
  v_permlane32_swap_b32 v55, v59
  v_add_f32 v52, v52, v56
  v_add_f32 v53, v53, v57
  v_add_f32 v54, v54, v58
  v_add_f32 v55, v55, v59
  s_nop 0
  v_permlane16_swap_b32 v52, v54
  v_permlane16_swap_b32 v53, v55
  v_add_f32 v52, v52, v54
  v_add_f32 v53, v53, v55
  v_mov_b32 v54, 1
  v_mov_b32 v55, 1
  v_add_f32_dpp v52, v52, v52 row_ror:8 row_mask:0xf bank_mask:0xf
  v_add_f32_dpp v53, v53, v53 row_ror:8 row_mask:0xf bank_mask:0xf
  ds_write_b128 v62, v[52:55] offset:2048
  s_cmp_lg_u32 s63, 0
  s_cbranch_scc1 L_pollq0
  s_mov_b32 s65, 524288
L_qred:
  ds_read_b128 v[12:15], v63 offset:2048
  ds_read_b128 v[16:19], v63 offset:2560
  ds_read_b128 v[20:23], v63 offset:3072
  ds_read_b128 v[24:27], v63 offset:3584
  s_waitcnt lgkmcnt(0)
  v_and_b32 v28, v14, v18
  v_and_b32 v29, v22, v26
  v_and_b32 v28, v28, v29
  v_cmp_ne_u32 vcc, 1, v28
  s_cbranch_vccz L_qred_ok
  s_sub_u32 s65, s65, 1
  s_cmp_lg_u32 s65, 0
  s_cbranch_scc1 L_qred
L_qred_ok:
  v_pk_add_f32 v[12:13], v[12:13], v[16:17]
  v_pk_add_f32 v[20:21], v[20:21], v[24:25]
  v_add_f32 v16, v12, v20
  v_add_f32 v18, v13, v21
  v_mov_b32 v17, s76
  v_mov_b32 v19, s76
  s_lshl_b32 s64, s3, 14
  s_lshl_b32 s65, s4, 12
  s_add_u32 s64, s64, s65
  s_and_b32 s65, s5, 1
  s_lshl_b32 s65, s65, 11
  s_add_u32 s64, s64, s65
  s_and_b32 s65, s5, 6
  s_lshl_b32 s65, s65, 8
  s_add_u32 s64, s64, s65
  s_add_u32 s64, s64, 65536
  s_mov_b64 exec, 0xffffffff
  buffer_store_dwordx4 v[16:19], v63, s[56:59], s64 offen sc1
  s_mov_b64 exec, -1
L_pollq0:
  s_cmp_lg_u32 s2, 0
  s_cbranch_scc1 L_noz
  v_mov_b64 v[12:13], 0
  v_mov_b32 v16, s53
  s_mov_b32 s64, 950272
  s_mov_b32 s65, 954368
  v_lshrrev_b32 v14, 4, v0
  v_mul_u32_u24 v14, 256, v14
  v_and_b32 v15, 15, v0
  v_lshl_add_u32 v14, v15, 3, v14
  buffer_store_dwordx2 v[12:13], v14, s[56:59], s64 offen sc1
  buffer_store_dwordx2 v[12:13], v14, s[56:59], s65 offen sc1
  v_lshlrev_b32 v14, 3, v1
  s_mov_b32 s64, 966656
  s_lshl_b32 s64, s63, 2
  s_add_u32 s64, s64, 917504
  s_waitcnt vmcnt(0)
  s_mov_b64 exec, 1
  buffer_store_dword v16, v2, s[56:59], s64 offen sc1
  s_mov_b64 exec, -1
L_noz:
  s_lshl_b32 s64, s3, 14
  s_lshl_b32 s65, s63, 12
  s_add_u32 s7, s64, s65
  s_add_u32 s7, s7, 65536
  s_sleep 96
  s_mov_b32 s65, 65536
L_pl84:
  buffer_load_dwordx4 v[12:15], v1, s[56:59], s7 offen offset:0 sc1
  buffer_load_dwordx4 v[16:19], v1, s[56:59], s7 offen offset:1024 sc1
  buffer_load_dwordx4 v[20:23], v1, s[56:59], s7 offen offset:2048 sc1
  buffer_load_dwordx4 v[24:27], v1, s[56:59], s7 offen offset:3072 sc1
L_pw84:
  s_waitcnt vmcnt(0)
  v_xor_b32 v28, s76, v13
  v_bitop3_b32 v28, v15, s76, v28 bitop3:0xbe
  v_bitop3_b32 v28, v17, s76, v28 bitop3:0xbe
  v_bitop3_b32 v28, v19, s76, v28 bitop3:0xbe
  v_bitop3_b32 v28, v21, s76, v28 bitop3:0xbe
  v_bitop3_b32 v28, v23, s76, v28 bitop3:0xbe
  v_bitop3_b32 v28, v25, s76, v28 bitop3:0xbe
  v_bitop3_b32 v28, v27, s76, v28 bitop3:0xbe
  v_cmp_le_u32 vcc, 16, v28
  s_cbranch_vccz L_plok84
  s_mov_b64 exec, vcc
  s_sleep 4
  s_sub_u32 s65, s65, 1
  s_cmp_lg_u32 s65, 0
  s_cbranch_scc1 L_pl84
L_plok84:
  s_mov_b64 exec, -1
  v_cmp_ne_u32 vcc, 0, v28
  v_add_f32 v12, v12, v20
  v_add_f32 v14, v14, v22
  v_add_f32 v16, v16, v24
  v_add_f32 v18, v18, v26
  v_cvt_pk_bf16_f32 v12, v12, v14
  v_cvt_pk_bf16_f32 v16, v16, v18
  v_lshrrev_b32 v13, 2, v1
  s_lshl_b32 s64, s63, 9
  v_add_u32 v13, s64, v13
  ds_write2_b32 v13, v12, v16 offset0:0 offset1:64
  s_lshl_b32 s64, s63, 2
  v_mov_b32 v14, s64
  v_mov_b32 v15, 1
  s_cbranch_vccz L_isloc
  ds_write_b32 v2, v15 offset:4128
L_isloc:
  s_waitcnt lgkmcnt(0)
  ds_write_b32 v14, v15 offset:4096
  s_setprio 0
  buffer_load_dwordx4 v[44:47], v1, s[44:47], 0 offen
  buffer_load_dwordx4 v[48:51], v1, s[48:51], 0 offen
  s_bitcmp1_b32 s5, 0
  s_cselect_b32 exec_hi, 0xffff, -1
  buffer_load_dwordx2 v[96:97], v7, s[40:43], s54 offen offset:0 nt
  buffer_load_dwordx2 v[98:99], v7, s[40:43], s54 offen offset:896 nt
  buffer_load_dwordx2 v[100:101], v7, s[40:43], s54 offen offset:1792 nt
  buffer_load_dwordx2 v[102:103], v7, s[40:43], s54 offen offset:2688 nt
  s_add_u32 s54, s54, 3584
  buffer_load_dwordx2 v[104:105], v7, s[40:43], s54 offen offset:0 nt
  buffer_load_dwordx2 v[106:107], v7, s[40:43], s54 offen offset:896 nt
  buffer_load_dwordx2 v[108:109], v7, s[40:43], s54 offen offset:1792 nt
  buffer_load_dwordx2 v[110:111], v7, s[40:43], s54 offen offset:2688 nt
  s_add_u32 s54, s54, 3584
  buffer_load_dwordx2 v[112:113], v7, s[40:43], s54 offen offset:0 nt
  buffer_load_dwordx2 v[114:115], v7, s[40:43], s54 offen offset:896 nt
  buffer_load_dwordx2 v[116:117], v7, s[40:43], s54 offen offset:1792 nt
  buffer_load_dwordx2 v[118:119], v7, s[40:43], s54 offen offset:2688 nt
  s_add_u32 s54, s54, 3584
  buffer_load_dwordx2 v[120:121], v7, s[40:43], s54 offen offset:0 nt
  buffer_load_dwordx2 v[122:123], v7, s[40:43], s54 offen offset:896 nt
  buffer_load_dwordx2 v[124:125], v7, s[40:43], s54 offen offset:1792 nt
  buffer_load_dwordx2 v[126:127], v7, s[40:43], s54 offen offset:2688 nt
  s_mov_b64 exec, -1
  s_waitcnt vmcnt(16)
  v_lshlrev_b32 v52, 16, v44
  v_and_b32 v53, s72, v44
  v_lshlrev_b32 v54, 16, v48
  v_and_b32 v55, s72, v48
  v_pk_mul_f32 v[56:57], v[52:53], v[54:55]
  v_lshlrev_b32 v52, 16, v45
  v_and_b32 v53, s72, v45
  v_lshlrev_b32 v54, 16, v49
  v_and_b32 v55, s72, v49
  v_pk_fma_f32 v[56:57], v[52:53], v[54:55], v[56:57]
  v_lshlrev_b32 v52, 16, v46
  v_and_b32 v53, s72, v46
  v_lshlrev_b32 v54, 16, v50
  v_and_b32 v55, s72, v50
  v_pk_fma_f32 v[56:57], v[52:53], v[54:55], v[56:57]
  v_lshlrev_b32 v52, 16, v47
  v_and_b32 v53, s72, v47
  v_lshlrev_b32 v54, 16, v51
  v_and_b32 v55, s72, v51
  v_pk_fma_f32 v[56:57], v[52:53], v[54:55], v[56:57]
  v_add_f32 v56, v56, v57
  s_nop 1
  v_add_f32_dpp v56, v56, v56 quad_perm:[1,0,3,2] row_mask:0xf bank_mask:0xf
  s_nop 1
  v_add_f32_dpp v56, v56, v56 quad_perm:[2,3,0,1] row_mask:0xf bank_mask:0xf
  s_nop 1
  v_add_f32_dpp v56, v56, v56 row_half_mirror row_mask:0xf bank_mask:0xf
  s_nop 1
  v_add_f32_dpp v56, v56, v56 row_mirror row_mask:0xf bank_mask:0xf
  v_mov_b32 v57, v56
  s_nop 1
  v_permlane16_swap_b32 v56, v57
  v_add_f32 v56, v56, v57
  v_mov_b32 v57, v56
  s_nop 1
  v_permlane32_swap_b32 v56, v57
  v_add_f32 v56, v56, v57
  v_mul_f32 v56, 0xbfb8aa3b, v56
  v_exp_f32 v56, v56
  s_nop 0
  v_add_f32 v56, 1.0, v56
  v_rcp_f32 v56, v56
  s_nop 0
  v_sub_f32 v57, 1.0, v56
  v_readfirstlane_b32 s74, v56
  v_readfirstlane_b32 s75, v57
  s_cmp_lt_u32 s4, 2
  s_cselect_b32 s74, s74, s75
  s_waitcnt vmcnt(0)
  v_lshlrev_b32 v8, 16, v96
  v_and_b32 v9, s72, v96
  v_lshlrev_b32 v10, 16, v97
  v_and_b32 v11, s72, v97
  v_lshlrev_b32 v12, 16, v98
  v_and_b32 v13, s72, v98
  v_lshlrev_b32 v14, 16, v99
  v_and_b32 v15, s72, v99
  v_lshlrev_b32 v16, 16, v100
  v_and_b32 v17, s72, v100
  v_lshlrev_b32 v18, 16, v101
  v_and_b32 v19, s72, v101
  v_lshlrev_b32 v20, 16, v102
  v_and_b32 v21, s72, v102
  v_lshlrev_b32 v22, 16, v103
  v_and_b32 v23, s72, v103
  v_lshlrev_b32 v24, 16, v104
  v_and_b32 v25, s72, v104
  v_lshlrev_b32 v26, 16, v105
  v_and_b32 v27, s72, v105
  v_lshlrev_b32 v28, 16, v106
  v_and_b32 v29, s72, v106
  v_lshlrev_b32 v30, 16, v107
  v_and_b32 v31, s72, v107
  v_lshlrev_b32 v32, 16, v108
  v_and_b32 v33, s72, v108
  v_lshlrev_b32 v34, 16, v109
  v_and_b32 v35, s72, v109
  v_lshlrev_b32 v36, 16, v110
  v_and_b32 v37, s72, v110
  v_lshlrev_b32 v38, 16, v111
  v_and_b32 v39, s72, v111
  v_lshlrev_b32 v40, 16, v112
  v_and_b32 v41, s72, v112
  v_lshlrev_b32 v42, 16, v113
  v_and_b32 v43, s72, v113
  v_lshlrev_b32 v44, 16, v114
  v_and_b32 v45, s72, v114
  v_lshlrev_b32 v46, 16, v115
  v_and_b32 v47, s72, v115
  v_lshlrev_b32 v48, 16, v116
  v_and_b32 v49, s72, v116
  v_lshlrev_b32 v50, 16, v117
  v_and_b32 v51, s72, v117
  v_lshlrev_b32 v52, 16, v118
  v_and_b32 v53, s72, v118
  v_lshlrev_b32 v54, 16, v119
  v_and_b32 v55, s72, v119
  v_lshlrev_b32 v56, 16, v120
  v_and_b32 v57, s72, v120
  v_lshlrev_b32 v58, 16, v121
  v_and_b32 v59, s72, v121
  v_lshlrev_b32 v60, 16, v122
  v_and_b32 v61, s72, v122
  v_lshlrev_b32 v62, 16, v123
  v_and_b32 v63, s72, v123
  v_lshlrev_b32 v64, 16, v124
  v_and_b32 v65, s72, v124
  v_lshlrev_b32 v66, 16, v125
  v_and_b32 v67, s72, v125
  v_lshlrev_b32 v68, 16, v126
  v_and_b32 v69, s72, v126
  v_lshlrev_b32 v70, 16, v127
  v_and_b32 v71, s72, v127
  s_and_b32 s77, s5, 7
  s_lshl_b32 s64, s3, 2
  s_add_u32 s64, s64, s4
  s_lshl_b32 s68, s64, 8
  s_add_u32 s68, s68, 983040
  s_mul_i32 s70, s64, 20480
  s_add_u32 s70, s70, 1572864
  s_mul_i32 s64, s3, 36864
  s_add_u32 s64, s64, 1048576
  s_and_b32 s65, s77, 6
  s_lshl_b32 s65, s65, 1
  s_add_u32 s65, s65, s63
  s_movk_i32 s71, 640
  s_cmp_eq_u32 s4, 1
  s_cselect_b32 s70, s64, s70
  s_cselect_b32 s64, 6, 5
  s_cselect_b32 s71, 1152, s71
  s_lshl_b32 s65, s65, s64
  s_add_u32 s70, s70, s65
  s_sub_u32 s64, s64, 1
  v_lshrrev_b32 v73, 5, v1
  v_mul_u32_u24 v92, s71, v73
  v_and_b32 v4, 1, v0
  v_lshl_add_u32 v92, v4, s64, v92
  v_lshlrev_b32 v73, 3, v73
  v_lshlrev_b32 v72, 4, v0
  v_lshlrev_b32 v95, 2, v0
  s_lshr_b32 s65, s55, 3
  s_sub_u32 s65, 256, s65
  v_cmp_gt_u32 s[80:81], s65, v0
  v_lshlrev_b32 v75, 3, v0
  s_lshl_b32 s64, s63, 2
  v_mov_b32 v94, s64
  v_mov_b32 v5, 1
  v_mov_b32 v162, 0
  s_mov_b64 s[66:67], -1
  s_mul_i32 s69, s3, 24
  s_add_u32 s69, s69, s77
  s_lshl_b32 s69, s69, 11
  s_add_u32 s69, s69, 524288
  s_mov_b32 s65, 524288
L_lw85:
  ds_read_b128 v[76:79], v2 offset:4096
  s_waitcnt lgkmcnt(0)
  v_and_b32 v76, v76, v77
  v_and_b32 v78, v78, v79
  v_and_b32 v76, v76, v78
  v_cmp_ne_u32 vcc, 1, v76
  s_cbranch_vccz L_lwok85
  s_sleep 2
  s_sub_u32 s65, s65, 1
  s_cmp_lg_u32 s65, 0
  s_cbranch_scc1 L_lw85
L_lwok85:
  ds_read_b32 v76, v2 offset:4128
  s_waitcnt lgkmcnt(0)
  v_readfirstlane_b32 s78, v76
  s_lshl_b32 s83, s63, 2
  s_add_u32 s83, s83, 917504
  s_mov_b32 s16, 0
  s_mov_b32 s17, 1087897600
  s_mov_b32 s18, 3207036928
  s_mov_b32 s19, 634912768
  s_mov_b32 s20, 1140850688
  s_mov_b32 s26, 1082130432
  s_mov_b32 s27, 880803840
  s_mov_b32 s44, s30
  s_mov_b32 s45, s31
  v_lshlrev_b32 v74, 1, v0
  v_lshrrev_b32 v93, 4, v0
  v_mul_u32_u24 v93, 256, v93
  v_and_b32 v4, 15, v0
  v_lshl_add_u32 v93, v4, 3, v93
  s_cmp_lg_u32 s4, 1
  s_cbranch_scc1 L_nozw
  s_mov_b32 s65, 65536
L_pl86:
  buffer_load_dword v76, v2, s[56:59], s83 offen sc1
L_pw86:
  s_waitcnt vmcnt(0)
  v_xor_b32 v88, s53, v76
  v_cmp_ne_u32 vcc, 0, v88
  s_cbranch_vccz L_plok86
  s_mov_b64 exec, vcc
  s_sleep 8
  s_sub_u32 s65, s65, 1
  s_cmp_lg_u32 s65, 0
  s_cbranch_scc1 L_pl86
L_plok86:
  s_mov_b64 exec, -1
L_nozw:
  s_mul_i32 s82, s55, 8
  s_add_u32 s82, s82, 950272
  s_lshl_b32 s21, s55, 7
  s_add_u32 s21, s21, 262144
  s_cmp_eq_u32 s63, 1
  s_cbranch_scc1 L_nocomb
  s_mov_b32 s64, 4116
  s_cmp_eq_u32 s63, 0
  s_cselect_b32 s64, 4112, s64
  v_mov_b32 v4, s64
  s_lshl_b32 s76, s3, 2
  s_add_u32 s76, s76, s63
  s_lshl_b32 s76, s76, 5
  s_add_u32 s76, s76, s5
  s_lshl_b32 s79, s76, 3
  s_add_u32 s79, s79, 983040
  s_mul_i32 s76, s76, 640
  s_add_u32 s76, s76, 1572864
  v_mov_b32 v160, s62
  s_lshl_b32 s64, s63, 13
  v_add_u32 v161, s64, v1
  v_lshrrev_b32 v6, 1, v1
  s_mov_b32 s65, 524288
L_lw87:
  ds_read_b32 v76, v4 offset:0
  s_waitcnt lgkmcnt(0)
  v_cmp_ne_u32 vcc, 8, v76
  s_cbranch_vccz L_lwok87
  s_sleep 4
  s_sub_u32 s65, s65, 1
  s_cmp_lg_u32 s65, 0
  s_cbranch_scc1 L_lw87
L_lwok87:
  ds_read_b128 v[96:99], v160 offset:4352
  ds_read_b128 v[100:103], v160 offset:4368
  ds_read_b128 v[104:107], v160 offset:4384
  ds_read_b128 v[108:111], v160 offset:4400
  ds_read_b128 v[112:115], v161 offset:5120
  ds_read_b128 v[116:119], v161 offset:6144
  ds_read_b128 v[120:123], v161 offset:7168
  ds_read_b128 v[124:127], v161 offset:8192
  ds_read_b128 v[128:131], v161 offset:9216
  ds_read_b128 v[132:135], v161 offset:10240
  ds_read_b128 v[136:139], v161 offset:11264
  ds_read_b128 v[140:143], v161 offset:12288
  v_mov_b32 v155, s53
  s_waitcnt lgkmcnt(8)
  v_max3_f32 v156, v96, v98, v100
  v_max3_f32 v157, v102, v104, v106
  v_max3_f32 v156, v156, v108, v110
  v_max_f32 v156, v156, v157
  v_sub_f32 v96, v96, v156
  v_sub_f32 v98, v98, v156
  v_sub_f32 v100, v100, v156
  v_sub_f32 v102, v102, v156
  v_sub_f32 v104, v104, v156
  v_sub_f32 v106, v106, v156
  v_sub_f32 v108, v108, v156
  v_sub_f32 v110, v110, v156
  v_exp_f32 v96, v96
  v_exp_f32 v98, v98
  v_exp_f32 v100, v100
  v_exp_f32 v102, v102
  v_exp_f32 v104, v104
  v_exp_f32 v106, v106
  v_exp_f32 v108, v108
  v_exp_f32 v110, v110
  v_mul_f32 v157, v96, v97
  v_mul_f32 v158, v98, v99
  v_fmac_f32 v157, v100, v101
  v_fmac_f32 v158, v102, v103
  v_fmac_f32 v157, v104, v105
  v_fmac_f32 v158, v106, v107
  v_fmac_f32 v157, v108, v109
  v_fmac_f32 v158, v110, v111
  v_add_f32 v157, v157, v158
  v_log_f32 v154, v157
  v_rcp_f32 v157, v157
  v_add_f32 v154, v154, v156
  v_mul_f32 v144, v96, v157
  v_mul_f32 v145, v98, v157
  v_mul_f32 v146, v100, v157
  v_mul_f32 v147, v102, v157
  v_mul_f32 v148, v104, v157
  v_mul_f32 v149, v106, v157
  v_mul_f32 v150, v108, v157
  v_mul_f32 v151, v110, v157
  s_waitcnt lgkmcnt(0)
  v_pk_mul_f32 v[156:157], v[112:113], v[144:145] op_sel_hi:[1,0]
  v_pk_mul_f32 v[158:159], v[114:115], v[144:145] op_sel_hi:[1,0]
  v_pk_fma_f32 v[156:157], v[116:117], v[144:145], v[156:157] op_sel:[0,1,0]
  v_pk_fma_f32 v[158:159], v[118:119], v[144:145], v[158:159] op_sel:[0,1,0]
  v_pk_fma_f32 v[156:157], v[120:121], v[146:147], v[156:157] op_sel_hi:[1,0,1]
  v_pk_fma_f32 v[158:159], v[122:123], v[146:147], v[158:159] op_sel_hi:[1,0,1]
  v_pk_fma_f32 v[156:157], v[124:125], v[146:147], v[156:157] op_sel:[0,1,0]
  v_pk_fma_f32 v[158:159], v[126:127], v[146:147], v[158:159] op_sel:[0,1,0]
  v_pk_fma_f32 v[156:157], v[128:129], v[148:149], v[156:157] op_sel_hi:[1,0,1]
  v_pk_fma_f32 v[158:159], v[130:131], v[148:149], v[158:159] op_sel_hi:[1,0,1]
  v_pk_fma_f32 v[156:157], v[132:133], v[148:149], v[156:157] op_sel:[0,1,0]
  v_pk_fma_f32 v[158:159], v[134:135], v[148:149], v[158:159] op_sel:[0,1,0]
  v_pk_fma_f32 v[156:157], v[136:137], v[150:151], v[156:157] op_sel_hi:[1,0,1]
  v_pk_fma_f32 v[158:159], v[138:139], v[150:151], v[158:159] op_sel_hi:[1,0,1]
  v_pk_fma_f32 v[156:157], v[140:141], v[150:151], v[156:157] op_sel:[0,1,0]
  v_pk_fma_f32 v[158:159], v[142:143], v[150:151], v[158:159] op_sel:[0,1,0]
  v_cvt_pk_bf16_f32 v152, v156, v157
  v_cvt_pk_bf16_f32 v153, v158, v159
  s_cmp_eq_u32 s78, 0
  s_cbranch_scc1 L_dp88
  buffer_store_dwordx2 v[152:153], v6, s[56:59], s76 offen sc1
  s_waitcnt vmcnt(0)
  s_mov_b64 exec, 1
  buffer_store_dwordx2 v[154:155], v2, s[56:59], s79 offen sc1
  s_mov_b64 exec, -1
  s_branch L_dq88
L_dp88:
  buffer_store_dwordx2 v[152:153], v6, s[56:59], s76 offen
  s_waitcnt vmcnt(0)
  s_mov_b64 exec, 1
  buffer_store_dwordx2 v[154:155], v2, s[56:59], s79 offen
  s_mov_b64 exec, -1
L_dq88:
L_nocomb:
  s_cmp_lg_u32 s4, 1
  s_cbranch_scc1 L_go0
  s_add_u32 s64, s69, 0x4000
  s_add_u32 s79, s69, 0x8000
  s_lshl_b32 s83, s3, 3
  s_add_u32 s83, s83, s77
  s_lshr_b32 s83, s83, 1
  s_lshl_b32 s83, s83, 11
  s_add_u32 s83, s83, s21
  v_mov_b32 v141, s53
  v_mov_b32 v143, s53
  v_mov_b32 v145, s53
  s_mov_b64 s[60:61], s[80:81]
  s_mov_b64 s[80:81], 0
  s_mov_b64 s[66:67], 0
  s_mov_b64 vcc, 0
  s_mov_b64 s[28:29], 0
  s_mov_b64 s[24:25], 0
  s_mov_b64 exec, 0
L_late:
  s_mov_b32 s65, 524288
L_lw89:
  ds_read_b32 v76, v2 offset:4256
  s_waitcnt lgkmcnt(0)
  v_cmp_ne_u32 vcc, 1, v76
  s_cbranch_vccz L_lwok89
  s_sleep 4
  s_sub_u32 s65, s65, 1
  s_cmp_lg_u32 s65, 0
  s_cbranch_scc1 L_lw89
L_lwok89:
  v_not_b32 v83, s53
  buffer_load_dwordx2 v[150:151], v73, s[56:59], s68 offen sc1
  s_bitcmp0_b32 s63, 0
  s_cselect_b64 exec, exec, 0
  buffer_load_dwordx4 v[76:79], v92, s[56:59], s70 offen sc1
  s_mov_b64 exec, s[80:81]
  buffer_load_dwordx2 v[140:141], v75, s[56:59], s69 offen sc1
  buffer_load_dwordx2 v[142:143], v75, s[56:59], s64 offen sc1
  buffer_load_dwordx2 v[144:145], v75, s[56:59], s79 offen sc1
  s_mov_b64 exec, s[66:67]
  s_waitcnt vmcnt(4)
  v_cmp_ne_u32 vcc, s53, v151
  s_cmp_eq_u32 s4, 1
  s_cbranch_vccz L_nodl
  s_mov_b64 exec, vcc
  s_branch L_go1
L_go0:
  s_mov_b32 s65, 524288
L_lw90:
  ds_read_b32 v76, v2 offset:4116
  s_waitcnt lgkmcnt(0)
  v_cmp_ne_u32 vcc, 8, v76
  s_cbranch_vccz L_lwok90
  s_sleep 4
  s_sub_u32 s65, s65, 1
  s_cmp_lg_u32 s65, 0
  s_cbranch_scc1 L_lw90
L_lwok90:
  s_max_u32 s64, s4, 1
  s_sub_u32 s64, s64, 1
  s_lshl_b32 s64, s64, 14
  s_add_u32 s69, s69, s64
  s_sleep 8
  s_cmp_eq_u32 s4, 0
  s_cbranch_scc1 L_go1
  s_sleep 16
L_go1:
  s_mov_b32 s65, 65536
L_pl91:
  buffer_load_dwordx2 v[150:151], v73, s[56:59], s68 offen sc1
L_pw91:
  s_waitcnt vmcnt(0)
  v_xor_b32 v88, s53, v151
  v_cmp_ne_u32 vcc, 0, v88
  s_cbranch_vccz L_plok91
  s_mov_b64 exec, vcc
  s_sleep 8
  s_sub_u32 s65, s65, 1
  s_cmp_lg_u32 s65, 0
  s_cbranch_scc1 L_pl91
L_plok91:
  s_mov_b64 exec, s[66:67]
  s_cmp_eq_u32 s4, 1
  s_cbranch_scc1 L_nodl
  buffer_load_dwordx4 v[78:81], v92, s[56:59], s70 offen sc1
L_nodl:
  v_max_f32_dpp v88, v150, v150 quad_perm:[2,3,0,1] row_mask:0xf bank_mask:0xf
  s_nop 1
  v_max_f32_dpp v88, v88, v88 row_half_mirror row_mask:0xf bank_mask:0xf
  s_nop 1
  v_max_f32_dpp v88, v88, v88 row_mirror row_mask:0xf bank_mask:0xf
  v_mov_b32 v89, v88
  s_nop 1
  v_permlane16_swap_b32 v88, v89
  v_max_f32 v88, v88, v89
  v_mov_b32 v89, v88
  s_nop 1
  v_permlane32_swap_b32 v88, v89
  v_max_f32 v88, v88, v89
  v_sub_f32 v90, v150, v88
  v_exp_f32 v90, v90
  s_nop 1
  v_add_f32_dpp v86, v90, v90 quad_perm:[2,3,0,1] row_mask:0xf bank_mask:0xf
  s_nop 1
  v_add_f32_dpp v86, v86, v86 row_half_mirror row_mask:0xf bank_mask:0xf
  s_nop 1
  v_add_f32_dpp v86, v86, v86 row_mirror row_mask:0xf bank_mask:0xf
  v_mov_b32 v87, v86
  s_nop 1
  v_permlane16_swap_b32 v86, v87
  v_add_f32 v86, v86, v87
  v_mov_b32 v87, v86
  s_nop 1
  v_permlane32_swap_b32 v86, v87
  v_add_f32 v86, v86, v87
  v_rcp_f32 v86, v86
  v_mul_f32 v90, s74, v90
  v_mul_f32 v90, v90, v86
  v_mov_b32 v85, s53
  s_waitcnt vmcnt(0)
  s_cbranch_scc0 L_go3
  s_mov_b32 s65, 524288
L_lw92:
  ds_read_b32 v88, v2 offset:4120
  s_waitcnt lgkmcnt(0)
  v_cmp_gt_u32 vcc, 6, v88
  s_cbranch_vccz L_lwok92
  s_sleep 1
  s_sub_u32 s65, s65, 1
  s_cmp_lg_u32 s65, 0
  s_cbranch_scc1 L_lw92
L_lwok92:
  v_xor_b32 v88, s53, v141
  v_bitop3_b32 v88, v143, s53, v88 bitop3:0xbe
  v_bitop3_b32 v88, v145, s53, v88 bitop3:0xbe
  v_cmp_ne_u32 s[28:29], 0, v88
  v_xor_b32 v88, s53, v79
  v_bitop3_b32 v88, v83, s53, v88 bitop3:0xbe
  v_cmp_ne_u32 vcc, 0, v88
  s_mov_b32 s65, 65536
  s_cbranch_vccz L_gpok
L_gp:
  s_mov_b64 exec, vcc
  buffer_load_dwordx4 v[76:79], v92, s[56:59], s70 offen sc1
  buffer_load_dwordx4 v[80:83], v92, s[56:59], s70 offen offset:16 sc1
  s_cmp_eq_u64 s[28:29], 0
  s_cbranch_scc1 L_gq
  s_mov_b64 exec, s[28:29]
  buffer_load_dwordx2 v[140:141], v75, s[56:59], s69 offen sc1
  buffer_load_dwordx2 v[142:143], v75, s[56:59], s64 offen sc1
  buffer_load_dwordx2 v[144:145], v75, s[56:59], s79 offen sc1
  s_waitcnt vmcnt(0)
  v_xor_b32 v88, s53, v141
  v_bitop3_b32 v88, v143, s53, v88 bitop3:0xbe
  v_bitop3_b32 v88, v145, s53, v88 bitop3:0xbe
  v_cmp_ne_u32 s[28:29], 0, v88
  s_mov_b64 exec, vcc
  s_sleep 1
L_gq:
  s_waitcnt vmcnt(0)
  v_xor_b32 v88, s53, v79
  v_bitop3_b32 v88, v83, s53, v88 bitop3:0xbe
  v_cmp_ne_u32 vcc, 0, v88
  s_sub_u32 s65, s65, 1
  s_cbranch_vccz L_gpok
  s_sleep 1
  s_cbranch_scc0 L_gp
L_gpok:
  s_mov_b64 exec, s[66:67]
L_go2:
  v_lshlrev_b32 v96, 16, v76
  v_and_b32 v97, s72, v76
  v_lshlrev_b32 v98, 16, v77
  v_and_b32 v99, s72, v77
  v_lshlrev_b32 v100, 16, v80
  v_and_b32 v101, s72, v80
  v_lshlrev_b32 v102, 16, v81
  v_and_b32 v103, s72, v81
  v_pk_mul_f32 v[96:97], v[96:97], v[90:91] op_sel_hi:[1,0]
  v_pk_mul_f32 v[98:99], v[98:99], v[90:91] op_sel_hi:[1,0]
  v_pk_mul_f32 v[100:101], v[100:101], v[90:91] op_sel_hi:[1,0]
  v_pk_mul_f32 v[102:103], v[102:103], v[90:91] op_sel_hi:[1,0]
  v_permlane32_swap_b32 v96, v98
  v_permlane32_swap_b32 v97, v99
  v_permlane32_swap_b32 v100, v102
  v_permlane32_swap_b32 v101, v103
  v_pk_add_f32 v[96:97], v[96:97], v[98:99]
  v_pk_add_f32 v[100:101], v[100:101], v[102:103]
  s_nop 1
  v_permlane16_swap_b32 v96, v100
  v_permlane16_swap_b32 v97, v101
  v_pk_add_f32 v[96:97], v[96:97], v[100:101]
  s_nop 1
  v_add_f32_dpp v96, v96, v96 row_ror:8 row_mask:0xf bank_mask:0xf
  v_add_f32_dpp v97, v97, v97 row_ror:8 row_mask:0xf bank_mask:0xf
  s_nop 0
  v_add_f32_dpp v96, v96, v96 row_ror:4 row_mask:0xf bank_mask:0xf
  v_add_f32_dpp v97, v97, v97 row_ror:4 row_mask:0xf bank_mask:0xf
  s_nop 0
  v_add_f32_dpp v96, v96, v96 row_ror:2 row_mask:0xf bank_mask:0xf
  v_add_f32_dpp v97, v97, v97 row_ror:2 row_mask:0xf bank_mask:0xf
  v_readlane_b32 s8, v96, 0
  v_readlane_b32 s9, v97, 0
  v_readlane_b32 s10, v96, 32
  v_readlane_b32 s11, v97, 32
  v_readlane_b32 s12, v96, 16
  v_readlane_b32 s13, v97, 16
  v_readlane_b32 s14, v96, 48
  v_readlane_b32 s15, v97, 48
  v_readlane_b32 s36, v96, 1
  v_readlane_b32 s37, v97, 1
  v_readlane_b32 s38, v96, 33
  v_readlane_b32 s39, v97, 33
  v_readlane_b32 s40, v96, 17
  v_readlane_b32 s41, v97, 17
  v_readlane_b32 s42, v96, 49
  v_readlane_b32 s43, v97, 49
  v_pk_mul_f32 v[104:105], v[8:9], s[8:9] op_sel_hi:[1,0]
  v_pk_mul_f32 v[106:107], v[10:11], s[8:9] op_sel_hi:[1,0]
  v_pk_mul_f32 v[108:109], v[12:13], s[8:9] op_sel:[0,1]
  v_pk_mul_f32 v[110:111], v[14:15], s[8:9] op_sel:[0,1]
  v_pk_fma_f32 v[104:105], v[16:17], s[10:11], v[104:105] op_sel_hi:[1,0,1]
  v_pk_fma_f32 v[106:107], v[18:19], s[10:11], v[106:107] op_sel_hi:[1,0,1]
  v_pk_fma_f32 v[108:109], v[20:21], s[10:11], v[108:109] op_sel:[0,1,0]
  v_pk_fma_f32 v[110:111], v[22:23], s[10:11], v[110:111] op_sel:[0,1,0]
  v_pk_fma_f32 v[104:105], v[24:25], s[12:13], v[104:105] op_sel_hi:[1,0,1]
  v_pk_fma_f32 v[106:107], v[26:27], s[12:13], v[106:107] op_sel_hi:[1,0,1]
  v_pk_fma_f32 v[108:109], v[28:29], s[12:13], v[108:109] op_sel:[0,1,0]
  v_pk_fma_f32 v[110:111], v[30:31], s[12:13], v[110:111] op_sel:[0,1,0]
  v_pk_fma_f32 v[104:105], v[32:33], s[14:15], v[104:105] op_sel_hi:[1,0,1]
  v_pk_fma_f32 v[106:107], v[34:35], s[14:15], v[106:107] op_sel_hi:[1,0,1]
  v_pk_fma_f32 v[108:109], v[36:37], s[14:15], v[108:109] op_sel:[0,1,0]
  v_pk_fma_f32 v[110:111], v[38:39], s[14:15], v[110:111] op_sel:[0,1,0]
  v_pk_fma_f32 v[104:105], v[40:41], s[36:37], v[104:105] op_sel_hi:[1,0,1]
  v_pk_fma_f32 v[106:107], v[42:43], s[36:37], v[106:107] op_sel_hi:[1,0,1]
  v_pk_fma_f32 v[108:109], v[44:45], s[36:37], v[108:109] op_sel:[0,1,0]
  v_pk_fma_f32 v[110:111], v[46:47], s[36:37], v[110:111] op_sel:[0,1,0]
  v_pk_fma_f32 v[104:105], v[48:49], s[38:39], v[104:105] op_sel_hi:[1,0,1]
  v_pk_fma_f32 v[106:107], v[50:51], s[38:39], v[106:107] op_sel_hi:[1,0,1]
  v_pk_fma_f32 v[108:109], v[52:53], s[38:39], v[108:109] op_sel:[0,1,0]
  v_pk_fma_f32 v[110:111], v[54:55], s[38:39], v[110:111] op_sel:[0,1,0]
  v_pk_fma_f32 v[104:105], v[56:57], s[40:41], v[104:105] op_sel_hi:[1,0,1]
  v_pk_fma_f32 v[106:107], v[58:59], s[40:41], v[106:107] op_sel_hi:[1,0,1]
  v_pk_fma_f32 v[108:109], v[60:61], s[40:41], v[108:109] op_sel:[0,1,0]
  v_pk_fma_f32 v[110:111], v[62:63], s[40:41], v[110:111] op_sel:[0,1,0]
  v_pk_fma_f32 v[104:105], v[64:65], s[42:43], v[104:105] op_sel_hi:[1,0,1]
  v_pk_fma_f32 v[106:107], v[66:67], s[42:43], v[106:107] op_sel_hi:[1,0,1]
  v_pk_fma_f32 v[108:109], v[68:69], s[42:43], v[108:109] op_sel:[0,1,0]
  v_pk_fma_f32 v[110:111], v[70:71], s[42:43], v[110:111] op_sel:[0,1,0]
  v_pk_add_f32 v[104:105], v[104:105], v[108:109]
  v_pk_add_f32 v[106:107], v[106:107], v[110:111]
  ds_write_b128 v72, v[104:107] offset:37888
  s_and_b64 exec, exec, 1
  ds_write_b32 v94, v5 offset:4144
  s_mov_b64 exec, s[66:67]
  ds_read_b128 v[96:99], v2 offset:4144
  ds_read2st64_b32 v[76:77], v95 offset0:148 offset1:152
  ds_read2st64_b32 v[78:79], v95 offset0:156 offset1:160
  s_cmp_lg_u32 s4, 1
  s_cbranch_scc1 L_ys0
  s_cmp_eq_u64 s[28:29], 0
  s_cbranch_scc1 L_yeok
  s_mov_b64 exec, s[28:29]
  s_mov_b32 s65, 65536
L_pl93:
  buffer_load_dwordx2 v[140:141], v75, s[56:59], s69 offen sc1
  buffer_load_dwordx2 v[142:143], v75, s[56:59], s64 offen sc1
  buffer_load_dwordx2 v[144:145], v75, s[56:59], s79 offen sc1
L_pw93:
  s_waitcnt vmcnt(0)
  v_xor_b32 v88, s53, v141
  v_bitop3_b32 v88, v143, s53, v88 bitop3:0xbe
  v_bitop3_b32 v88, v145, s53, v88 bitop3:0xbe
  v_cmp_ne_u32 vcc, 0, v88
  s_cbranch_vccz L_plok93
  s_mov_b64 exec, vcc
  s_sleep 1
  s_sub_u32 s65, s65, 1
  s_cmp_lg_u32 s65, 0
  s_cbranch_scc1 L_pl93
L_plok93:
  s_mov_b64 exec, -1
L_yeok:
  v_add_f32 v162, v140, v142
  v_add_f32 v162, v162, v144
L_ys0:
  s_mov_b32 s65, 524288
L_ysw:
  s_waitcnt lgkmcnt(2)
  v_and_b32 v96, v96, v97
  v_bitop3_b32 v96, v96, v98, v99 bitop3:0x80
  v_cmp_ne_u32 vcc, 1, v96
  s_waitcnt lgkmcnt(0)
  s_cbranch_vccnz L_ys
L_ysok:
  v_pk_add_f32 v[76:77], v[76:77], v[78:79]
  s_cmp_lg_u32 s4, 1
  s_mov_b64 exec, s[80:81]
  v_add_f32 v76, v76, v162
  v_add_f32 v84, v76, v77
  s_cbranch_scc1 L_yearly
  v_cvt_f64_f32 v[80:81], v84
  v_cmp_lt_f32 s[24:25], s27, abs(v84)
  v_cmp_nlt_f32 vcc, abs(v84), s26
  v_add_f64 v[76:77], v[80:81], s[16:17]
  s_cmp_eq_u64 s[24:25], 0
  s_cbranch_vccnz L_raw
  s_cbranch_scc1 L_raw
L_atom:
  buffer_atomic_add_x2 v[76:77], v93, s[56:59], s82 offen sc0 sc1
  v_add_f64 v[80:81], v[80:81], s[16:17]
  v_add_u32 v81, s19, v81
  s_add_u32 s7, s63, s55
  s_waitcnt vmcnt(0)
  v_lshl_add_u64 v[76:77], v[76:77], 0, v[80:81]
  v_add_f64 v[80:81], v[76:77], -s[16:17]
  v_cvt_f32_f64 v80, v[80:81]
  v_cmp_gt_f32 vcc, s20, abs(v80)
L_ost:
  v_cvt_pk_bf16_f32 v80, v80, v80
  s_mov_b64 exec, vcc
  buffer_store_short v80, v74, s[44:47], s55 offen
  s_cmp_lg_u32 s7, 0
  s_cbranch_scc1 L_noep
  s_and_b64 exec, vcc, 1
  buffer_store_dword v85, v2, s[56:59], 0 offen
L_noep:
  s_mov_b64 exec, s[80:81]
  v_add_u32 v96, s18, v77
  v_cmp_gt_u32 vcc, 0x400000, v96
  s_cbranch_vccz L_tend
  s_mov_b64 exec, vcc
  v_and_b32 v97, 0xffff, v96
  v_add_u32 v77, 1087864832, v97
  v_lshrrev_b32 v96, 16, v96
  v_add_f64 v[82:83], v[76:77], -s[16:17]
  v_cvt_f32_f64 v82, v[82:83]
  s_movk_i32 s65, 0x400
  s_add_u32 s22, s21, 65536
L_sc0:
  v_mov_b32 v97, -1
  v_mov_b32 v80, v82
  s_mov_b32 s64, s21
L_sc1:
  buffer_load_dwordx2 v[100:101], v75, s[56:59], s64 offen sc1
  s_add_u32 s64, s64, 0x800
  s_waitcnt vmcnt(0)
  v_cmp_eq_u32 vcc, s53, v101
  s_nop 1
  v_cndmask_b32 v100, 0, v100, vcc
  v_addc_co_u32 v97, vcc, 0, v97, vcc
  v_add_f32 v80, v80, v100
  s_cmp_lt_u32 s64, s22
  s_cbranch_scc1 L_sc1
  v_cmp_ne_u32 vcc, v96, v97
  s_cbranch_vccz L_sc2
  s_sub_u32 s65, s65, 1
  s_cmp_lg_u32 s65, 0
  s_cbranch_scc1 L_sc0
L_sc2:
  s_mov_b64 vcc, exec
  s_branch L_ost
L_raw:
  buffer_store_dwordx2 v[84:85], v75, s[56:59], s83 offen sc1
  v_mov_b32 v76, 0
  v_mov_b32 v77, 1087963136
  v_mov_b32 v80, 0
  v_mov_b32 v81, 0x40900000
  s_branch L_atom
L_go3:
  v_mov_b64 v[76:77], v[78:79]
  s_branch L_go2
L_tend:
  s_cmp_lg_u32 s66, 0
  s_cbranch_scc1 L_end
  s_mov_b64 s[66:67], -1
  s_mov_b64 s[80:81], s[60:61]
  s_mov_b64 exec, -1
  s_branch L_late
L_ys:
  s_sub_u32 s65, s65, 1
  s_cmp_eq_u32 s65, 0
  s_cbranch_scc1 L_ysok
  ds_read_b128 v[96:99], v2 offset:4144
  ds_read2st64_b32 v[76:77], v95 offset0:148 offset1:152
  ds_read2st64_b32 v[78:79], v95 offset0:156 offset1:160
  s_branch L_ysw
L_yearly:
  s_cmp_eq_u32 s78, 0
  s_cbranch_scc1 L_dp94
  buffer_store_dwordx2 v[84:85], v75, s[56:59], s69 offen sc1
  s_branch L_dq94
L_dp94:
  buffer_store_dwordx2 v[84:85], v75, s[56:59], s69 offen
L_dq94:
  s_mov_b64 exec, -1
L_end:
  s_endpgm
.section .rodata,"a"
.p2align 6
.amdhsa_kernel gated_mix__mha_block_cached__gqa_block_cached__decode_kernel
  .amdhsa_next_free_vgpr 168
  .amdhsa_next_free_sgpr 100
  .amdhsa_accum_offset 168
  .amdhsa_group_segment_fixed_size 0
  .amdhsa_kernarg_size 112
  .amdhsa_user_sgpr_count 2
  .amdhsa_user_sgpr_kernarg_segment_ptr 1
  .amdhsa_system_sgpr_workgroup_id_x 1
.end_amdhsa_kernel
```
